```python
import torch

def _softmax(x, axis=-1):
    return torch.softmax(x, dim=axis)
def _gelu(x):
    return torch.nn.functional.gelu(x, approximate="tanh")
def _silu(x):
    return torch.nn.functional.silu(x)
def _sigmoid(x):
    return torch.sigmoid(x)
def _layernorm(x, axis=-1, eps=1e-5):
    m = x.mean(dim=axis, keepdim=True)
    v = x.var(dim=axis, keepdim=True, unbiased=False)
    return (x - m) / torch.sqrt(v + eps)
def _scatter_add(tgt, idx, src, axis=0):
    return tgt.clone().index_add_(axis, idx, src)
def _segment_sum(src, seg, n):
    out = torch.zeros((n,) + src.shape[1:], dtype=src.dtype)
    return out.index_add_(0, seg, src)
def _pad(x, pw):
    flat = tuple(v for pair in reversed(pw) for v in pair)
    return torch.nn.functional.pad(x, flat)

kernel_name = 'recurrent_scan__ssm_conv_s4__moe_arch_mod__prompt'

def setup_inputs():

    _w = (lambda a: (lambda t: t.to(torch.bfloat16) if t.is_floating_point() else t)(torch.as_tensor(a)))
    def _A_setup():
        B, L, D, N = 1, 2048, 512, 128
        A_re = -(lambda _x: torch.exp(torch.as_tensor(_x)))((lambda *s: torch.randn(*s, dtype=torch.bfloat16) * 6.4)(D, N))
        A_im = torch.pi * (lambda *s: torch.randn(*s, dtype=torch.bfloat16) * 0.05)(D, N)
        B_re = (lambda *s: torch.randn(*s, dtype=torch.bfloat16) * 0.1)(D, N)
        B_im = (lambda *s: torch.randn(*s, dtype=torch.bfloat16) * 0.1)(D, N)
        C_re = (lambda *s: torch.randn(*s, dtype=torch.bfloat16) * 0.1)(D, N)
        C_im = (lambda *s: torch.randn(*s, dtype=torch.bfloat16) * 0.1)(D, N)
        log_dt = (lambda *s: torch.randn(*s, dtype=torch.bfloat16) * 0.05)(D) * 0.5 - 4.0
        Dskip = (lambda *s: torch.randn(*s, dtype=torch.bfloat16) * 0.05)(D)
        return {
            "u": _w((lambda *s: torch.randn(*s, dtype=torch.bfloat16) * 0.05)(B, L, D)),
            "A_re": _w(A_re),
            "A_im": _w(A_im),
            "B_re": _w(B_re),
            "B_im": _w(B_im),
            "C_re": _w(C_re),
            "C_im": _w(C_im),
            "log_dt": _w(log_dt),
            "Dskip": _w(Dskip),
        }
    _A_in = _A_setup()

    def _B_setup():
        B, S, D, F, C = 1, 2048, 512, 1792, 2
        return {
            "x": _w((lambda *s: torch.randn(*s, dtype=torch.bfloat16) * 0.05)(B, S, D)),
            "w_r": _w((lambda *s: torch.randn(*s, dtype=torch.bfloat16) * 3.2)(D)),
            "w_gate": _w((lambda *s: torch.randn(*s, dtype=torch.bfloat16) * 0.05)(D, F)),
            "w_up": _w((lambda *s: torch.randn(*s, dtype=torch.bfloat16) * 0.05)(D, F)),
            "w_down": _w((lambda *s: torch.randn(*s, dtype=torch.bfloat16) * 0.05)(F, D)),
        }
    _B_in = _B_setup()

    return {
        "A_u": _A_in["u"],
        "A_A_re": _A_in["A_re"],
        "A_A_im": _A_in["A_im"],
        "A_B_re": _A_in["B_re"],
        "A_B_im": _A_in["B_im"],
        "A_C_re": _A_in["C_re"],
        "A_C_im": _A_in["C_im"],
        "A_log_dt": _A_in["log_dt"],
        "A_Dskip": _A_in["Dskip"],
        "B_x": _B_in["x"],
        "B_w_r": _B_in["w_r"],
        "B_w_gate": _B_in["w_gate"],
        "B_w_up": _B_in["w_up"],
        "B_w_down": _B_in["w_down"],
    }

def reference(A_u, A_A_re, A_A_im, A_B_re, A_B_im, A_C_re, A_C_im, A_log_dt, A_Dskip, B_x, B_w_r, B_w_gate, B_w_up, B_w_down):
    def _A_ref(u, A_re, A_im, B_re, B_im, C_re, C_im, log_dt, Dskip):
        Bsz, L, D = u.shape
        dt = torch.exp(log_dt)[:, None]
        A = A_re + 1j * A_im
        Bc = B_re + 1j * B_im
        Cc = C_re + 1j * C_im
        logdA = dt * A
        dB = dt * Bc
        l = (lambda x, dt: x.to(dt))(torch.arange(L), A_re.dtype)
        P = torch.exp(logdA[:, :, None] * l[None, None, :])
        K = torch.einsum("dn,dnl,dn->dl", Cc, P, dB).real
        L2 = 2 * L
        Kp = _pad(K, ((0, 0), (0, L)))
        up = (lambda x, *d: x.permute(*d))(u, 0, 2, 1)
        up = _pad(up, ((0, 0), (0, 0), (0, L)))
        Kf = (lambda x, axes=(-2,-1): torch.fft.rfft2(x.float(), dim=axes))(Kp[:, None, :], axes=(-2, -1))
        Uf = (lambda x, axes=(-2,-1): torch.fft.rfft2(x.float(), dim=axes))(up[:, :, None, :], axes=(-2, -1))
        Yf = Uf * Kf[None, :, :, :]
        y = (lambda x, s, axes=(-2,-1): torch.fft.irfft2(x, s=s, dim=axes).to(torch.bfloat16))(Yf, (1, L2), axes=(-2, -1))[:, :, 0, :L]
        y = (lambda x, *d: x.permute(*d))(y, 0, 2, 1) + u * Dskip[None, None, :]
        return y

    def _B_ref(x, w_r, w_gate, w_up, w_down):
        B, S, D = x.shape
        C = 2
        r = x @ w_r
        idx = torch.argsort(-r, axis=-1)[:, :C]
        idx_e = (lambda x, n, axis: torch.repeat_interleave(x, n, dim=axis))(idx.reshape(B, C, 1), D, axis=2)
        x_sel = (lambda x, i, axis: torch.take_along_dim(x, i, dim=axis))(x, idx_e, axis=1)
        g = _silu(x_sel @ w_gate)
        u = x_sel @ w_up
        y = (g * u) @ w_down
        r_sel = _sigmoid((lambda x, i, axis: torch.take_along_dim(x, i, dim=axis))(r, idx, axis=1))
        y = y * r_sel.reshape(B, C, 1)
        b_off = (torch.arange(B) * S).reshape(B, 1)
        flat_idx = (idx + b_off).reshape(B * C)
        zero = (x * 0.0).reshape(B * S, D)
        upd = _scatter_add(zero, flat_idx, y.reshape(B * C, D), axis=0)
        return x + upd.reshape(B, S, D)

    x = A_u
    xn = _layernorm(x, axis=-1)
    s = _A_ref(xn, A_A_re, A_A_im, A_B_re, A_B_im, A_C_re, A_C_im, A_log_dt, A_Dskip)
    g = _silu(_B_ref(xn, B_w_r, B_w_gate, B_w_up, B_w_down))
    return x + s * g
```

```asm
; @launch grid=(512,1,1) block=(256,1,1) lds=78976
.amdgcn_target "amdgcn-amd-amdhsa--gfx950"
.text
.globl recurrent_scan__ssm_conv_s4__moe_arch_mod__prompt_kernel
.p2align 8
.type recurrent_scan__ssm_conv_s4__moe_arch_mod__prompt_kernel,@function
recurrent_scan__ssm_conv_s4__moe_arch_mod__prompt_kernel:
    s_cmp_ge_u32 s2, 512
    s_cbranch_scc1 L_end
    s_load_dwordx16 s[4:19], s[0:1], 0
    s_load_dwordx16 s[20:35], s[0:1], 64
    s_load_dwordx2 s[36:37], s[0:1], 128
    s_getpc_b64 s[46:47]
L_pc:
    s_lshr_b32 s45, s2, 3
    s_lshl_b32 s45, s45, 8
    v_and_b32 v2, 0xc0, v0
    v_add_u32_e64 v2, s45, v2
    v_min_u32 v2, L_end-L_pc, v2
    global_load_dword v251, v2, s[46:47]
    v_lshrrev_b32_e64 v1, 6, v0
    s_bfe_u32 s49, s2, 0x50003
    s_and_b32 s48, s2, 7
    v_readfirstlane_b32 s40, v1
    s_lshl_b32 s39, s48, 5
    s_add_u32 s39, s39, s49
    v_and_b32_e64 v1, 63, v0
    s_cmp_ge_u32 s2, 256
    s_cbranch_scc1 L_row
    s_lshl_b32 s45, s39, 9
    v_lshl_add_u32 v2, v0, 1, s45
    s_lshl_b32 s45, s39, 2
    v_lshrrev_b32 v3, 7, v0
    v_lshl_add_u32 v3, v3, 1, s45
    s_waitcnt lgkmcnt(0)
    s_nop 0
    global_load_ushort v14, v3, s[18:19] nt
    global_load_ushort v8, v2, s[6:7] nt
    global_load_ushort v9, v2, s[8:9] nt
    global_load_ushort v10, v2, s[10:11] nt
    global_load_ushort v11, v2, s[12:13] nt
    global_load_ushort v12, v2, s[14:15] nt
    global_load_ushort v13, v2, s[16:17] nt
    s_load_dword s38, s[36:37], 0
    s_branch L_conv
L_row:
    s_setprio 3
    v_lshlrev_b32 v2, 4, v1
    s_lshl_b32 s59, s39, 2
    s_add_u32 s59, s59, s40
    s_lshl_b32 s46, s59, 11
    v_add_u32 v3, s46, v2
    v_lshlrev_b32 v4, 4, v0
    s_lshl_b32 s61, s39, 13
    v_mov_b32 v68, -1
    v_mov_b32 v69, -1
    v_mov_b32 v70, -1
    v_mov_b32_e64 v71, -1
    s_add_u32 s46, s61, 3149824
    v_add_u32 v246, s46, v4
    v_lshrrev_b32 v35, 1, v0
    v_and_b32 v36, 1, v0
    v_lshlrev_b32 v37, 3, v35
    s_lshl_b32 s46, s59, 6
    s_add_u32 s46, s46, 65536
    v_mul_u32_u24 v247, 5439488, v36
    v_add_u32 v247, s46, v247
    s_waitcnt lgkmcnt(0)
    s_nop 0
    global_load_dword v247, v247, s[36:37]
    global_load_dwordx4 v[16:19], v2, s[24:25]
    global_load_dwordx4 v[8:11], v3, s[4:5] nt
    global_load_dwordx4 v[12:15], v3, s[4:5] offset:1024 nt
    s_load_dword s38, s[36:37], 0
    global_load_dwordx2 v[32:33], v37, s[20:21]
    s_and_b32 s45, s48, 1
    s_lshl_b32 s54, s45, 3
    s_sub_u32 s54, 32, s54
    s_lshr_b32 s72, s48, 1
    s_mul_i32 s72, s72, 7
    s_lshl_b32 s45, s45, 2
    s_add_u32 s72, s72, s45
    s_lshl_b32 s60, s72, 2
    s_lshr_b32 s45, s54, 1
    s_sub_u32 s58, s49, s45
    s_add_u32 s60, s60, s58
    s_cmp_lt_u32 s58, s45
    s_cselect_b32 s58, 0, 99
    s_sub_u32 s45, s54, 1
    s_min_u32 s45, s45, s49
    s_lshr_b32 s45, s45, 3
    s_add_u32 s72, s72, s45
    v_lshrrev_b32 v38, 3, v1
    s_and_b32 s46, s49, 7
    s_lshl_b32 s46, s46, 6
    s_and_b32 s45, s40, 1
    s_lshl_b32 s62, s45, 12
    s_lshl_b32 s45, s45, 5
    s_add_u32 s46, s46, s45
    v_add_u32 v38, s46, v38
    s_movk_i32 s46, 3584
    v_mul_lo_u32 v38, v38, s46
    v_and_b32 v39, 7, v1
    v_lshl_add_u32 v38, v39, 4, v38
    s_lshl_b32 s46, s72, 7
    v_add_u32 v240, s46, v38
    s_add_u32 s62, s62, 20480
    s_lshl_b32 s73, s48, 8
    s_add_u32 s73, s73, 196608
    v_mov_b32 v3, s73
    v_lshl_add_u32 v34, v36, 12, v37
    v_add_u32_e64 v34, s61, v34
    s_mov_b32 s47, 0x3f803f80
    s_mov_b32 s67, 0x3b000000
    s_mov_b32 s66, 3216550459
    s_mul_i32 s46, s40, 2176
    v_add_u32_e64 v7, s46, v2
    s_add_u32 s46, s61, 1052672
    v_add_u32_e64 v5, s46, v4
    v_mul_u32_u24 v6, 4352, v36
    v_add_u32_e64 v6, v6, v37
    s_mov_b32 s63, 0x7fff7fff
    s_mov_b32 s64, 0x32003200
    s_mov_b32 s65, 0x80008000
    s_mov_b32 s55, 0x0fff0fff
    s_lshl_b32 s46, s59, 3
    s_add_u32 s46, s46, 65536
    v_and_b32 v39, 1, v1
    v_lshl_add_u32 v201, v39, 13, s46
    v_lshrrev_b32 v38, 4, v1
    v_lshlrev_b32 v38, 3, v38
    v_bfe_u32 v39, v1, 2, 2
    v_add_u32 v38, v38, v39
    v_lshlrev_b32 v38, 7, v38
    v_and_b32_e64 v39, 3, v1
    v_lshl_add_u32 v38, v39, 3, v38
    s_lshl_b32 s46, s40, 5
    v_add_u32 v195, s46, v38
    v_lshlrev_b32_e64 v38, 2, v0
    v_sub_u32 v38, 2047, v38
    v_subrev_u32 v156, 0, v38
    v_subrev_u32 v157, 1, v38
    v_subrev_u32 v158, 2, v38
    v_subrev_u32 v159, 3, v38
    v_subrev_u32 v160, 512, v38
    v_subrev_u32 v161, 513, v38
    v_subrev_u32 v162, 514, v38
    v_subrev_u32 v163, 515, v38
    v_subrev_u32 v164, 1024, v38
    v_subrev_u32 v165, 1025, v38
    v_subrev_u32 v166, 1026, v38
    v_subrev_u32 v167, 1027, v38
    v_subrev_u32 v168, 1536, v38
    v_subrev_u32 v169, 1537, v38
    v_subrev_u32 v170, 1538, v38
    v_subrev_u32 v171, 1539, v38
    s_lshl_b32 s46, s40, 3
    v_mov_b32 v188, s46
    v_and_b32 v38, 15, v0
    v_mov_b32 v189, 0
    s_mov_b32 s78, 0xaaaaaaaa
    s_mov_b32 s79, 0xaaaaaaaa
    s_and_b32 s45, s49, 7
    s_lshl_b32 s46, s45, 10
    s_add_u32 s46, s46, 1048576
    v_add_u32 v190, s46, v2
    s_lshl_b32 s46, s40, 8
    s_add_u32 s46, s46, 36864
    v_lshl_add_u32 v191, v1, 1, s46
    v_and_b32_e64 v39, 0x30, v1
    v_add_u32 v192, 36864, v39
    s_mul_i32 s46, s45, 1792
    s_lshl_b32 s45, s72, 6
    s_add_u32 s46, s46, s45
    s_lshl_b32 s45, s40, 4
    s_add_u32 s46, s46, s45
    s_lshl_b32 s46, s46, 4
    s_add_u32 s46, s46, 720896
    v_add_u32 v193, s46, v2
    v_add_u32 v245, 5046272, v193
    s_and_b32 s46, s48, 1
    s_lshl_b32 s46, s46, 13
    s_add_u32 s46, s46, 69632
    v_add_u32_e64 v194, s46, v4
    v_mov_b32 v203, 0xffffff00
    s_lshl_b32 s46, s60, 8
    s_add_u32 s46, s46, 5767168
    v_lshrrev_b32 v39, 4, v1
    v_mul_u32_u24 v39, 28672, v39
    v_lshl_add_u32 v39, v38, 4, v39
    v_add_u32_e64 v196, s46, v39
    v_add_u32 v197, 114688, v196
    s_lshl_b32 s46, s60, 12
    s_add_u32 s46, s46, 262144
    v_add_u32 v198, s46, v4
    s_lshl_b32 s46, s60, 14
    v_lshl_add_u32 v202, v0, 2, s46
    s_lshl_b32 s46, s39, 8
    s_add_u32 s46, s46, 5505024
    v_lshl_add_u32 v244, v36, 7, s46
    s_lshl_b32 s45, s39, 5
    s_add_u32 s45, s45, 3145728
    v_lshlrev_b32 v39, 14, v35
    v_lshl_add_u32 v39, v36, 4, v39
    v_add_u32_e64 v199, s45, v39
    v_add_u32 v200, 8192, v199
    v_bfe_u32 v38, v1, 2, 2
    v_mul_u32_u24 v38, 1088, v38
    v_and_b32 v39, 0xf0, v0
    v_lshl_add_u32 v38, v39, 1, v38
    v_and_b32_e64 v39, 3, v1
    v_lshl_add_u32 v38, v39, 3, v38
    s_waitcnt lgkmcnt(0)
    s_mul_i32 s45, s38, 1664525
    s_add_u32 s45, s45, 1013904223
    s_andn2_b32 s45, s45, 0x10001001
    s_andn2_b32 s38, 0x10001001, s38
    s_or_b32 s38, s38, s45
    s_and_b32 s41, s38, 0x70007000
    s_and_b32 s45, s38, 0x10001000
    s_lshl_b32 s42, s38, 3
    s_and_b32 s42, s42, 0x60006000
    s_or_b32 s42, s42, s45
    s_lshl_b32 s43, s38, 6
    s_and_b32 s43, s43, 0x60006000
    s_or_b32 s43, s43, s45
    s_lshl_b32 s44, s38, 9
    s_and_b32 s44, s44, 0x60006000
    s_or_b32 s44, s44, s45
    v_mov_b32 v20, s41
    v_mov_b32 v21, s42
    v_mov_b32 v22, s43
    v_mov_b32 v23, s44
    v_mov_b32_e64 v67, s38
    v_mov_b32 v39, 0xffff
    s_mov_b32 s46, 0xffff0000
    s_waitcnt vmcnt(3)
    v_dot2_f32_bf16 v62, v16, s47, 0
    v_dot2_f32_bf16 v62, v17, s47, v62
    v_dot2_f32_bf16 v62, v18, s47, v62
    v_dot2_f32_bf16 v62, v19, s47, v62
    s_nop 2
    v_mov_b32 v61, v62
    s_nop 1
    v_permlane32_swap_b32 v61, v62
    v_add_f32 v62, v61, v62
    global_store_dwordx4 v246, v[68:71], s[36:37] offset:-4096 sc1
    global_store_dwordx4 v246, v[68:71], s[36:37] sc1
    s_waitcnt vmcnt(3)
    s_nop 0
    v_dot2_f32_bf16 v56, v8, s47, 0
    v_dot2_f32_bf16 v57, v12, s47, 0
    v_dot2_f32_bf16 v58, v8, v8, 0
    v_dot2_f32_bf16 v59, v12, v12, 0
    v_dot2_f32_bf16 v60, v8, v16, 0
    v_dot2_f32_bf16 v61, v12, v16, 0
    v_dot2_f32_bf16 v56, v9, s47, v56
    v_dot2_f32_bf16 v57, v13, s47, v57
    v_dot2_f32_bf16 v58, v9, v9, v58
    v_dot2_f32_bf16 v59, v13, v13, v59
    v_dot2_f32_bf16 v60, v9, v17, v60
    v_dot2_f32_bf16 v61, v13, v17, v61
    v_dot2_f32_bf16 v56, v10, s47, v56
    v_dot2_f32_bf16 v57, v14, s47, v57
    v_dot2_f32_bf16 v58, v10, v10, v58
    v_dot2_f32_bf16 v59, v14, v14, v59
    v_dot2_f32_bf16 v60, v10, v18, v60
    v_dot2_f32_bf16 v61, v14, v18, v61
    v_dot2_f32_bf16 v56, v11, s47, v56
    v_dot2_f32_bf16 v57, v15, s47, v57
    v_dot2_f32_bf16 v58, v11, v11, v58
    v_dot2_f32_bf16 v59, v15, v15, v59
    v_dot2_f32_bf16 v60, v11, v19, v60
    v_dot2_f32_bf16 v61, v15, v19, v61
    v_permlane32_swap_b32 v56, v57
    v_permlane32_swap_b32 v58, v59
    v_add_f32 v56, v56, v57
    v_permlane32_swap_b32 v60, v61
    v_add_f32 v58, v58, v59
    v_add_f32 v60, v60, v61
    v_lshlrev_b32 v40, 16, v8
    v_permlane16_swap_b32 v56, v58
    v_permlane16_swap_b32 v60, v62
    v_add_f32 v56, v56, v58
    v_add_f32 v60, v60, v62
    v_and_b32 v41, s46, v8
    v_add_f32_dpp v56, v56, v56 quad_perm:[1,0,3,2] row_mask:0xf bank_mask:0xf
    v_add_f32_dpp v60, v60, v60 quad_perm:[1,0,3,2] row_mask:0xf bank_mask:0xf
    v_lshlrev_b32_e64 v42, 16, v9
    v_add_f32_dpp v56, v56, v56 quad_perm:[2,3,0,1] row_mask:0xf bank_mask:0xf
    v_add_f32_dpp v60, v60, v60 quad_perm:[2,3,0,1] row_mask:0xf bank_mask:0xf
    v_and_b32_e64 v43, s46, v9
    v_add_f32_dpp v56, v56, v56 row_half_mirror row_mask:0xf bank_mask:0xf
    v_add_f32_dpp v60, v60, v60 row_half_mirror row_mask:0xf bank_mask:0xf
    v_lshlrev_b32_e64 v44, 16, v10
    v_add_f32_dpp v56, v56, v56 row_mirror row_mask:0xf bank_mask:0xf
    v_add_f32_dpp v60, v60, v60 row_mirror row_mask:0xf bank_mask:0xf
    v_and_b32_e64 v45, s46, v10
    v_mov_b32_dpp v57, v56 row_bcast:15 row_mask:0xa bank_mask:0xf
    v_mov_b32_dpp v61, v60 row_bcast:15 row_mask:0xa bank_mask:0xf
    v_mul_f32 v57, s67, v57
    v_mul_f32 v58, v57, v57
    v_fma_f32 v56, v56, s67, -v58
    v_max_f32_e64 v56, 0, v56
    v_cvt_pk_bf16_f32 v56, 0, v56
    v_add_f32 v56, 0x3727c5ac, v56
    v_cvt_pk_bf16_f32 v56, 0, v56
    v_sqrt_f32_e64 v56, v56
    v_cvt_pk_bf16_f32 v57, 0, v57
    v_cvt_pk_bf16_f32 v56, 0, v56
    v_rcp_f32 v56, v56
    v_lshlrev_b32 v46, 16, v11
    v_mul_f32 v57, -v57, v56
    v_mul_f32_e64 v61, v61, v56
    v_readlane_b32 s50, v56, 31
    v_readlane_b32 s52, v56, 63
    v_fma_f32 v60, v60, v57, v61
    v_readlane_b32 s51, v57, 31
    v_readlane_b32 s53, v57, 63
    v_cvt_pk_bf16_f32 v60, v60, v60
    v_pk_ashrrev_i16 v61, 15, v60 op_sel_hi:[0,1]
    v_or_b32 v61, s65, v61
    v_xor_b32 v60, v60, v61
    v_and_b32 v47, s46, v11
    v_lshlrev_b32 v48, 16, v12
    v_mov_b32_dpp v61, v60 row_bcast:31 row_mask:0xc bank_mask:0xf
    v_bfi_b32 v66, v39, v61, v60
    s_mov_b32 exec_lo, 0
    s_mov_b32 exec_hi, 0xc0000000
    global_store_dwordx2 v201, v[66:67], s[36:37] sc1
    s_mov_b64 exec, -1
    v_and_b32 v49, s46, v12
    v_lshlrev_b32 v50, 16, v13
    v_and_b32 v51, s46, v13
    v_lshlrev_b32 v52, 16, v14
    v_and_b32 v53, s46, v14
    v_lshlrev_b32 v54, 16, v15
    v_and_b32 v55, s46, v15
    v_pk_fma_f32 v[40:41], v[40:41], s[50:51], s[50:51] op_sel:[0,0,1] op_sel_hi:[1,0,1]
    v_pk_fma_f32 v[42:43], v[42:43], s[50:51], s[50:51] op_sel:[0,0,1] op_sel_hi:[1,0,1]
    v_pk_fma_f32 v[44:45], v[44:45], s[50:51], s[50:51] op_sel:[0,0,1] op_sel_hi:[1,0,1]
    v_pk_fma_f32 v[46:47], v[46:47], s[50:51], s[50:51] op_sel:[0,0,1] op_sel_hi:[1,0,1]
    v_cvt_pk_bf16_f32 v68, v40, v41
    v_cvt_pk_bf16_f32 v69, v42, v43
    v_cvt_pk_bf16_f32 v70, v44, v45
    v_cvt_pk_bf16_f32 v71, v46, v47
    ds_write_b128 v7, v[68:71] offset:0
    v_pk_fma_f32 v[48:49], v[48:49], s[52:53], s[52:53] op_sel:[0,0,1] op_sel_hi:[1,0,1]
    v_pk_fma_f32 v[50:51], v[50:51], s[52:53], s[52:53] op_sel:[0,0,1] op_sel_hi:[1,0,1]
    v_pk_fma_f32 v[52:53], v[52:53], s[52:53], s[52:53] op_sel:[0,0,1] op_sel_hi:[1,0,1]
    v_pk_fma_f32 v[54:55], v[54:55], s[52:53], s[52:53] op_sel:[0,0,1] op_sel_hi:[1,0,1]
    v_cvt_pk_bf16_f32 v72, v48, v49
    v_cvt_pk_bf16_f32 v73, v50, v51
    v_cvt_pk_bf16_f32 v74, v52, v53
    v_cvt_pk_bf16_f32 v75, v54, v55
    ds_write_b128 v7, v[72:75] offset:1088
    s_waitcnt vmcnt(1) lgkmcnt(0)
    s_barrier
    ds_read_b64_tr_b16 v[76:77], v38
    ds_read_b64_tr_b16 v[78:79], v38 offset:4352
    ds_read_b64_tr_b16 v[80:81], v38 offset:512
    ds_read_b64_tr_b16 v[82:83], v38 offset:4864
    ds_read_b64 v[84:85], v6 offset:0
    ds_read_b64 v[86:87], v6 offset:1088
    ds_read_b64 v[88:89], v6 offset:2176
    ds_read_b64 v[90:91], v6 offset:3264
    s_waitcnt lgkmcnt(6)
    v_and_b32 v40, s63, v76
    v_and_b32 v41, s63, v77
    v_and_b32 v42, s63, v78
    v_and_b32_e64 v43, s63, v79
    v_pk_sub_u16 v40, v40, s64 clamp
    v_pk_sub_u16 v41, v41, s64 clamp
    v_pk_sub_u16 v42, v42, s64 clamp
    v_pk_sub_u16 v43, v43, s64 clamp
    v_and_or_b32 v76, v76, s65, v20
    v_and_or_b32 v77, v77, s65, v21
    v_and_or_b32 v78, v78, s65, v22
    v_and_or_b32 v79, v79, s65, v23
    v_bfi_b32 v76, s55, v40, v76
    v_bfi_b32 v77, s55, v41, v77
    v_bfi_b32 v78, s55, v42, v78
    v_bfi_b32 v79, s55, v43, v79
    global_store_dwordx4 v5, v[76:79], s[36:37] offset:-4096 sc1
    s_waitcnt lgkmcnt(4)
    v_and_b32 v40, s63, v80
    v_and_b32 v41, s63, v81
    v_and_b32 v42, s63, v82
    v_and_b32_e64 v43, s63, v83
    v_pk_sub_u16 v40, v40, s64 clamp
    v_pk_sub_u16 v41, v41, s64 clamp
    v_pk_sub_u16 v42, v42, s64 clamp
    v_pk_sub_u16 v43, v43, s64 clamp
    v_and_or_b32 v80, v80, s65, v20
    v_and_or_b32 v81, v81, s65, v21
    v_and_or_b32 v82, v82, s65, v22
    v_and_or_b32 v83, v83, s65, v23
    v_bfi_b32 v80, s55, v40, v80
    v_bfi_b32 v81, s55, v41, v81
    v_bfi_b32 v82, s55, v42, v82
    v_bfi_b32 v83, s55, v43, v83
    global_store_dwordx4 v5, v[80:83], s[36:37] offset:0 sc1
    s_setprio 1
    s_cmp_lt_u32 s40, 2
    s_cbranch_scc1 L_r_nogu
    s_add_u32 m0, s62, 0
    s_nop 0
    global_load_lds_dwordx4 v240, s[26:27] nt
    s_add_u32 m0, s62, 8192
    s_nop 0
    global_load_lds_dwordx4 v240, s[28:29] nt
    v_add_u32 v240, 28672, v240
    s_add_u32 m0, s62, 1024
    s_nop 0
    global_load_lds_dwordx4 v240, s[26:27] nt
    s_add_u32 m0, s62, 9216
    s_nop 0
    global_load_lds_dwordx4 v240, s[28:29] nt
    v_add_u32 v240, 28672, v240
    s_add_u32 m0, s62, 2048
    s_nop 0
    global_load_lds_dwordx4 v240, s[26:27] nt
    s_add_u32 m0, s62, 10240
    s_nop 0
    global_load_lds_dwordx4 v240, s[28:29] nt
    v_add_u32 v240, 28672, v240
    s_add_u32 m0, s62, 3072
    s_nop 0
    global_load_lds_dwordx4 v240, s[26:27] nt
    s_add_u32 m0, s62, 11264
    s_nop 0
    global_load_lds_dwordx4 v240, s[28:29] nt
L_r_nogu:
    s_cmp_ge_u32 s58, 14
    s_cbranch_scc1 L_r_npw
    s_cmp_lg_u32 s40, 3
    s_cbranch_scc1 L_r_npw
    global_load_dword v248, v196, s[36:37] sc1
    global_load_dword v247, v197, s[36:37] sc1
L_r_npw:
    ds_write_b128 v7, v[8:11] offset:10240
    ds_write_b128 v7, v[12:15] offset:11328
    s_waitcnt lgkmcnt(0)
    s_barrier
    ds_read_b64 v[24:25], v6 offset:10240
    ds_read_b64 v[26:27], v6 offset:11328
    ds_read_b64 v[28:29], v6 offset:12416
    ds_read_b64 v[30:31], v6 offset:13504
    s_waitcnt lgkmcnt(0)
    v_lshlrev_b32 v56, 16, v32
    v_and_b32 v57, 0xffff0000, v32
    v_lshlrev_b32_e64 v58, 16, v33
    v_and_b32 v59, 0xffff0000, v33
    v_lshlrev_b32_e64 v92, 16, v24
    v_and_b32 v93, 0xffff0000, v24
    v_lshlrev_b32_e64 v40, 16, v84
    v_and_b32 v41, 0xffff0000, v84
    v_lshlrev_b32_e64 v94, 16, v26
    v_and_b32 v95, 0xffff0000, v26
    v_lshlrev_b32_e64 v42, 16, v86
    v_and_b32 v43, 0xffff0000, v86
    v_lshlrev_b32_e64 v96, 16, v28
    v_and_b32 v97, 0xffff0000, v28
    v_lshlrev_b32_e64 v44, 16, v88
    v_and_b32 v45, 0xffff0000, v88
    v_lshlrev_b32_e64 v98, 16, v30
    v_and_b32 v99, 0xffff0000, v30
    v_lshlrev_b32_e64 v46, 16, v90
    v_and_b32 v47, 0xffff0000, v90
    v_lshlrev_b32_e64 v100, 16, v25
    v_and_b32 v101, 0xffff0000, v25
    v_lshlrev_b32_e64 v48, 16, v85
    v_and_b32 v49, 0xffff0000, v85
    v_lshlrev_b32_e64 v102, 16, v27
    v_and_b32 v103, 0xffff0000, v27
    v_lshlrev_b32_e64 v50, 16, v87
    v_and_b32 v51, 0xffff0000, v87
    v_lshlrev_b32_e64 v104, 16, v29
    v_and_b32 v105, 0xffff0000, v29
    v_lshlrev_b32_e64 v52, 16, v89
    v_and_b32 v53, 0xffff0000, v89
    v_lshlrev_b32_e64 v106, 16, v31
    v_and_b32 v107, 0xffff0000, v31
    v_lshlrev_b32_e64 v54, 16, v91
    v_and_b32 v55, 0xffff0000, v91
    v_pk_mul_f32 v[124:125], v[40:41], s[66:67] op_sel_hi:[1,0]
    v_pk_mul_f32 v[108:109], v[40:41], v[56:57]
    v_pk_mul_f32 v[126:127], v[42:43], s[66:67] op_sel_hi:[1,0]
    v_pk_mul_f32 v[110:111], v[42:43], v[56:57]
    v_pk_mul_f32 v[128:129], v[44:45], s[66:67] op_sel_hi:[1,0]
    v_pk_mul_f32 v[112:113], v[44:45], v[56:57]
    v_pk_mul_f32 v[130:131], v[46:47], s[66:67] op_sel_hi:[1,0]
    v_pk_mul_f32 v[114:115], v[46:47], v[56:57]
    v_pk_mul_f32 v[132:133], v[48:49], s[66:67] op_sel_hi:[1,0]
    v_pk_mul_f32 v[116:117], v[48:49], v[58:59]
    v_pk_mul_f32 v[134:135], v[50:51], s[66:67] op_sel_hi:[1,0]
    v_pk_mul_f32 v[118:119], v[50:51], v[58:59]
    v_pk_mul_f32 v[136:137], v[52:53], s[66:67] op_sel_hi:[1,0]
    v_pk_mul_f32 v[120:121], v[52:53], v[58:59]
    v_pk_mul_f32 v[138:139], v[54:55], s[66:67] op_sel_hi:[1,0]
    v_pk_mul_f32 v[122:123], v[54:55], v[58:59]
    v_exp_f32 v124, v124
    v_exp_f32 v125, v125
    v_exp_f32 v126, v126
    v_exp_f32 v127, v127
    v_exp_f32 v128, v128
    v_exp_f32 v129, v129
    v_exp_f32 v130, v130
    v_exp_f32 v131, v131
    v_exp_f32 v132, v132
    v_exp_f32 v133, v133
    v_exp_f32 v134, v134
    v_exp_f32 v135, v135
    v_exp_f32 v136, v136
    v_exp_f32 v137, v137
    v_exp_f32 v138, v138
    v_exp_f32 v139, v139
    v_pk_add_f32 v[124:125], v[124:125], 1.0 op_sel_hi:[1,0]
    v_pk_add_f32 v[126:127], v[126:127], 1.0 op_sel_hi:[1,0]
    v_pk_add_f32 v[128:129], v[128:129], 1.0 op_sel_hi:[1,0]
    v_pk_add_f32 v[130:131], v[130:131], 1.0 op_sel_hi:[1,0]
    v_pk_add_f32 v[132:133], v[132:133], 1.0 op_sel_hi:[1,0]
    v_pk_add_f32 v[134:135], v[134:135], 1.0 op_sel_hi:[1,0]
    v_pk_add_f32 v[136:137], v[136:137], 1.0 op_sel_hi:[1,0]
    v_pk_add_f32 v[138:139], v[138:139], 1.0 op_sel_hi:[1,0]
    v_rcp_f32 v124, v124
    v_rcp_f32 v125, v125
    v_rcp_f32 v126, v126
    v_rcp_f32 v127, v127
    v_rcp_f32 v128, v128
    v_rcp_f32 v129, v129
    v_rcp_f32 v130, v130
    v_rcp_f32 v131, v131
    v_rcp_f32 v132, v132
    v_rcp_f32 v133, v133
    v_rcp_f32 v134, v134
    v_rcp_f32 v135, v135
    v_rcp_f32 v136, v136
    v_rcp_f32 v137, v137
    v_rcp_f32 v138, v138
    v_rcp_f32 v139, v139
    v_pk_mul_f32 v[124:125], v[124:125], v[40:41]
    v_pk_mul_f32 v[126:127], v[126:127], v[42:43]
    v_pk_mul_f32 v[128:129], v[128:129], v[44:45]
    v_pk_mul_f32 v[130:131], v[130:131], v[46:47]
    v_pk_mul_f32 v[132:133], v[132:133], v[48:49]
    v_pk_mul_f32 v[134:135], v[134:135], v[50:51]
    v_pk_mul_f32 v[136:137], v[136:137], v[52:53]
    v_pk_mul_f32 v[138:139], v[138:139], v[54:55]
    v_pk_fma_f32 v[92:93], v[108:109], v[124:125], v[92:93]
    v_pk_fma_f32 v[94:95], v[110:111], v[126:127], v[94:95]
    v_pk_fma_f32 v[96:97], v[112:113], v[128:129], v[96:97]
    v_pk_fma_f32 v[98:99], v[114:115], v[130:131], v[98:99]
    v_pk_fma_f32 v[100:101], v[116:117], v[132:133], v[100:101]
    v_pk_fma_f32 v[102:103], v[118:119], v[134:135], v[102:103]
    v_pk_fma_f32 v[104:105], v[120:121], v[136:137], v[104:105]
    v_pk_fma_f32 v[106:107], v[122:123], v[138:139], v[106:107]
    s_cmp_ge_u32 s49, s54
    s_cbranch_scc1 L_r_pre
    s_mov_b32 s46, 0xffff0000
    s_bfe_u32 s41, s38, 524288
    s_bfe_u32 s42, s38, 524296
    s_bfe_u32 s43, s38, 524304
    s_bfe_u32 s44, s38, 524312
    s_cmp_lt_u32 s40, 2
    s_cbranch_scc1 L_r_p01
    s_waitcnt vmcnt(0)
    s_branch L_r_ka
L_r_p01:
    s_waitcnt vmcnt(0)
    s_mov_b32 s45, 20000
L_r_1:
    global_load_dwordx4 v[140:143], v194, s[36:37] offset:-4096 sc1
    global_load_dwordx4 v[144:147], v194, s[36:37] offset:-2048 sc1
    global_load_dwordx4 v[148:151], v194, s[36:37] offset:0 sc1
    global_load_dwordx4 v[152:155], v194, s[36:37] offset:2048 sc1
L_r_chk_3:
    s_waitcnt vmcnt(0)
    v_xor_b32 v141, s38, v141
    v_xor_b32 v143, s38, v143
    v_xor_b32 v145, s38, v145
    v_xor_b32 v147, s38, v147
    v_xor_b32 v149, s38, v149
    v_xor_b32 v151, s38, v151
    v_xor_b32 v153, s38, v153
    v_xor_b32 v155, s38, v155
    v_or3_b32 v56, v141, v143, v145
    v_or3_b32 v57, v147, v149, v151
    v_or3_b32 v56, v56, v153, v155
    v_or_b32 v56, v56, v57
    v_cmp_ne_u32 vcc, 0, v56
    s_cbranch_vccz L_r_done_2
    s_sub_u32 s45, s45, 1
    s_cbranch_scc1 L_r_done_2
    s_sleep 6
    s_branch L_r_1
L_r_done_2:
    s_setprio 2
    v_lshl_or_b32 v156, v140, 16, v156
    v_and_or_b32 v157, v140, s46, v157
    v_lshl_or_b32 v158, v142, 16, v158
    v_and_or_b32 v159, v142, s46, v159
    v_lshl_or_b32 v160, v144, 16, v160
    v_and_or_b32 v161, v144, s46, v161
    v_lshl_or_b32 v162, v146, 16, v162
    v_and_or_b32 v163, v146, s46, v163
    v_lshl_or_b32 v164, v148, 16, v164
    v_and_or_b32 v165, v148, s46, v165
    v_lshl_or_b32 v166, v150, 16, v166
    v_and_or_b32 v167, v150, s46, v167
    v_lshl_or_b32 v168, v152, 16, v168
    v_and_or_b32 v169, v152, s46, v169
    v_lshl_or_b32 v170, v154, 16, v170
    v_and_or_b32 v171, v154, s46, v171
    v_max_u32 v220, v156, v157
    v_min_u32 v221, v156, v157
    v_med3_u32 v222, v220, v158, v159
    v_max3_u32 v220, v220, v158, v159
    v_max_u32_e64 v221, v221, v222
    v_med3_u32 v222, v220, v160, v161
    v_max3_u32 v220, v220, v160, v161
    v_max_u32_e64 v221, v221, v222
    v_med3_u32 v222, v220, v162, v163
    v_max3_u32 v220, v220, v162, v163
    v_max_u32_e64 v221, v221, v222
    v_med3_u32 v222, v220, v164, v165
    v_max3_u32 v220, v220, v164, v165
    v_max_u32_e64 v221, v221, v222
    v_med3_u32 v222, v220, v166, v167
    v_max3_u32 v220, v220, v166, v167
    v_max_u32_e64 v221, v221, v222
    v_med3_u32 v222, v220, v168, v169
    v_max3_u32 v220, v220, v168, v169
    v_max_u32_e64 v221, v221, v222
    v_med3_u32 v222, v220, v170, v171
    v_max3_u32 v220, v220, v170, v171
    v_max_u32 v221, v221, v222
    s_nop 0
    v_min_u32_dpp v222, v220, v220 quad_perm:[1,0,3,2] row_mask:0xf bank_mask:0xf
    v_max_u32_dpp v220, v220, v220 quad_perm:[1,0,3,2] row_mask:0xf bank_mask:0xf
    v_max_u32_dpp v221, v221, v221 quad_perm:[1,0,3,2] row_mask:0xf bank_mask:0xf
    v_max_u32_e64 v221, v221, v222
    v_min_u32_dpp v222, v220, v220 quad_perm:[2,3,0,1] row_mask:0xf bank_mask:0xf
    v_max_u32_dpp v220, v220, v220 quad_perm:[2,3,0,1] row_mask:0xf bank_mask:0xf
    v_max_u32_dpp v221, v221, v221 quad_perm:[2,3,0,1] row_mask:0xf bank_mask:0xf
    v_max_u32_e64 v221, v221, v222
    v_min_u32_dpp v222, v220, v220 row_half_mirror row_mask:0xf bank_mask:0xf
    v_max_u32_dpp v220, v220, v220 row_half_mirror row_mask:0xf bank_mask:0xf
    v_max_u32_dpp v221, v221, v221 row_half_mirror row_mask:0xf bank_mask:0xf
    v_max_u32_e64 v221, v221, v222
    v_min_u32_dpp v222, v220, v220 row_mirror row_mask:0xf bank_mask:0xf
    v_max_u32_dpp v220, v220, v220 row_mirror row_mask:0xf bank_mask:0xf
    v_max_u32_dpp v221, v221, v221 row_mirror row_mask:0xf bank_mask:0xf
    v_max_u32_e64 v221, v221, v222
    v_min_u32_dpp v222, v220, v220 row_bcast:15 row_mask:0xa bank_mask:0xf
    v_max_u32_dpp v220, v220, v220 row_bcast:15 row_mask:0xa bank_mask:0xf
    v_max_u32_dpp v221, v221, v221 row_bcast:15 row_mask:0xa bank_mask:0xf
    v_max_u32_e64 v221, v221, v222
    v_min_u32_dpp v222, v220, v220 row_bcast:31 row_mask:0xc bank_mask:0xf
    v_max_u32_dpp v220, v220, v220 row_bcast:31 row_mask:0xc bank_mask:0xf
    v_max_u32_dpp v221, v221, v221 row_bcast:31 row_mask:0xc bank_mask:0xf
    v_max_u32_e64 v221, v221, v222
    v_readlane_b32 s68, v220, 63
    v_readlane_b32 s69, v221, 63
    s_andn2_b32 s70, 2047, s68
    s_andn2_b32 s71, 2047, s69
    s_lshr_b32 s74, s70, 3
    s_lshl_b32 s74, s74, 13
    v_add_u32 v11, s74, v190
    s_lshr_b32 s74, s71, 3
    s_lshl_b32 s74, s74, 13
    v_add_u32 v12, s74, v190
    global_load_dwordx4 v[40:43], v11, s[36:37] sc1
    global_load_dwordx4 v[44:47], v12, s[36:37] sc1
    s_lshl_b32 s74, s40, 12
    s_or_b32 s68, s68, s74
    s_or_b32 s69, s69, s74
    s_or_b32 s69, s69, 0x800
    v_mov_b32 v220, s68
    v_mov_b32_e64 v221, s69
    ds_write_b64 v188, v[220:221] offset:8704
    s_and_b32 s74, s70, 3
    s_mul_i32 s74, s74, 0x202
    s_add_u32 s74, s74, 0x0c0c0100
    s_bitcmp1_b32 s70, 2
    s_cselect_b32 s50, 0x0c0c0c0c, s74
    s_cselect_b32 s51, s74, 0x0c0c0c0c
    s_and_b32 s74, s71, 3
    s_mul_i32 s74, s74, 0x202
    s_add_u32 s74, s74, 0x0c0c0100
    s_bitcmp1_b32 s71, 2
    s_cselect_b32 s52, 0x0c0c0c0c, s74
    s_cselect_b32 s53, s74, 0x0c0c0c0c
L_r_ka:
    s_waitcnt lgkmcnt(0)
    s_barrier
    s_setprio 2
    s_nop 0
    ds_read_b128 v[212:215], v189 offset:8704
    ds_read_b64_tr_b16 v[172:173], v195 offset:20480
    ds_read_b64_tr_b16 v[180:181], v195 offset:28672
    ds_read_b64_tr_b16 v[174:175], v195 offset:20992
    ds_read_b64_tr_b16 v[182:183], v195 offset:29184
    ds_read_b64_tr_b16 v[176:177], v195 offset:24576
    ds_read_b64_tr_b16 v[184:185], v195 offset:32768
    ds_read_b64_tr_b16 v[178:179], v195 offset:25088
    ds_read_b64_tr_b16 v[186:187], v195 offset:33280
    s_cmp_ge_u32 s58, 14
    s_cbranch_scc1 L_r_wd
    global_load_dword v140, v202, s[30:31] offset:0 nt
    global_load_dword v141, v202, s[30:31] offset:1024 nt
    global_load_dword v142, v202, s[30:31] offset:2048 nt
    global_load_dword v143, v202, s[30:31] offset:3072 nt
    v_add_u32 v202, 4096, v202
    global_load_dword v144, v202, s[30:31] offset:0 nt
    global_load_dword v145, v202, s[30:31] offset:1024 nt
    global_load_dword v146, v202, s[30:31] offset:2048 nt
    global_load_dword v147, v202, s[30:31] offset:3072 nt
    v_add_u32 v202, 4096, v202
    global_load_dword v148, v202, s[30:31] offset:0 nt
    global_load_dword v149, v202, s[30:31] offset:1024 nt
    global_load_dword v150, v202, s[30:31] offset:2048 nt
    global_load_dword v151, v202, s[30:31] offset:3072 nt
    v_add_u32 v202, 4096, v202
    global_load_dword v152, v202, s[30:31] offset:0 nt
    global_load_dword v153, v202, s[30:31] offset:1024 nt
    global_load_dword v154, v202, s[30:31] offset:2048 nt
    global_load_dword v155, v202, s[30:31] offset:3072 nt
L_r_wd:
    s_waitcnt lgkmcnt(8)
    v_max_u32 v220, v212, v213
    v_min_u32_e64 v221, v212, v213
    v_med3_u32 v222, v220, v214, v215
    v_max3_u32 v220, v220, v214, v215
    v_max_u32 v221, v221, v222
    v_readfirstlane_b32 s68, v220
    v_readfirstlane_b32 s69, v221
    v_cndmask_b32 v222, v220, v221, s[78:79]
    v_bfe_u32 v222, v222, 11, 3
    v_lshl_add_u32 v192, v222, 7, v192
    s_andn2_b32 s70, 2047, s68
    s_andn2_b32 s71, 2047, s69
    s_cmp_ge_u32 s40, 2
    s_cbranch_scc1 L_r_kb
    s_waitcnt vmcnt(16)
    s_cmp_lt_u32 s58, 14
    s_cbranch_scc1 L_r_wd2
    s_waitcnt vmcnt(0)
L_r_wd2:
    v_xor_b32 v40, v20, v40
    v_xor_b32 v41, v21, v41
    v_xor_b32 v42, v22, v42
    v_xor_b32 v43, v23, v43
    v_xor_b32 v44, v20, v44
    v_xor_b32 v45, v21, v45
    v_xor_b32 v46, v22, v46
    v_xor_b32_e64 v47, v23, v47
    v_or3_b32 v56, v40, v41, v42
    v_or3_b32 v57, v43, v44, v45
    v_or3_b32 v56, v56, v46, v47
    v_or_b32_e64 v56, v56, v57
    v_and_b32 v56, 0x70007000, v56
    v_cmp_ne_u32 vcc, 0, v56
    s_cbranch_vccz L_r_xsok
    s_mov_b32 s45, 20000
L_xs_4:
    global_load_dwordx4 v[40:43], v11, s[36:37] sc1
    global_load_dwordx4 v[44:47], v12, s[36:37] sc1
L_xs_chk_6:
    s_waitcnt vmcnt(0)
    v_xor_b32 v40, v20, v40
    v_xor_b32 v41, v21, v41
    v_xor_b32 v42, v22, v42
    v_xor_b32 v43, v23, v43
    v_xor_b32 v44, v20, v44
    v_xor_b32 v45, v21, v45
    v_xor_b32 v46, v22, v46
    v_xor_b32_e64 v47, v23, v47
    v_or3_b32 v56, v40, v41, v42
    v_or3_b32 v57, v43, v44, v45
    v_or3_b32 v56, v56, v46, v47
    v_or_b32_e64 v56, v56, v57
    v_and_b32 v56, 0x70007000, v56
    v_cmp_ne_u32 vcc, 0, v56
    s_cbranch_vccz L_xs_done_5
    s_sub_u32 s45, s45, 1
    s_cbranch_scc1 L_xs_done_5
    s_sleep 1
    s_branch L_xs_4
L_xs_done_5:
L_r_xsok:
    v_perm_b32 v40, v41, v40, s50
    v_perm_b32 v42, v43, v42, s51
    v_add3_u32 v40, v40, v42, s64
    ds_write_b16 v191, v40 offset:0
    v_perm_b32 v44, v45, v44, s52
    v_perm_b32 v46, v47, v46, s53
    v_add3_u32 v44, v44, v46, s64
    ds_write_b16 v191, v44 offset:128
L_r_kb:
    s_waitcnt lgkmcnt(0)
    s_barrier
    ds_read_b128 v[232:235], v192 offset:0
    ds_read_b128 v[236:239], v192 offset:64
    s_waitcnt lgkmcnt(1)
    v_mfma_f32_16x16x32_bf16 v[224:227], v[232:235], v[172:175], 0
    v_mfma_f32_16x16x32_bf16 v[228:231], v[232:235], v[180:183], 0
    s_waitcnt lgkmcnt(0)
    v_mfma_f32_16x16x32_bf16 v[224:227], v[236:239], v[176:179], v[224:227]
    v_mfma_f32_16x16x32_bf16 v[228:231], v[236:239], v[184:187], v[228:231]
    s_nop 6
    s_nop 0
    v_and_or_b32 v226, v226, v203, s41
    v_and_or_b32 v227, v227, v203, s42
    v_and_or_b32 v228, v228, v203, s43
    v_and_or_b32 v229, v229, v203, s44
    s_mov_b64 exec, 0xffff
    global_store_dwordx4 v245, v[226:229], s[36:37]
    s_cmp_lt_u32 s58, 14
    s_cbranch_scc1 L_r_pdef
    global_store_dwordx4 v193, v[226:229], s[36:37] sc1
L_r_pdef:
    s_mov_b64 exec, -1
    s_or_b32 s74, s49, s40
    s_cmp_lg_u32 s74, 0
    s_cbranch_scc1 L_r_pre
    s_pack_hh_b32_b16 s72, s68, s69
    s_and_b32 s74, s72, 0x80008000
    s_lshr_b32 s75, s74, 15
    s_sub_u32 s75, s74, s75
    s_not_b32 s75, s75
    s_xor_b32 s72, s72, s75
    s_lshl_b32 s74, s71, 16
    s_or_b32 s74, s74, s70
    v_mov_b32 v204, s74
    v_mov_b32 v205, s72
    v_mov_b32 v207, s38
    s_mov_b64 exec, 1
    global_store_dwordx4 v3, v[204:207], s[36:37] sc1
    s_mov_b64 exec, -1
L_r_pre:
    s_cmp_ge_u32 s49, s54
    s_cbranch_scc1 L_r_noffn
    s_cmp_ge_u32 s58, 14
    s_cbranch_scc1 L_r_nost2
    s_mov_b32 s45, 20000
    global_load_dwordx4 v[204:207], v196, s[36:37] sc1
    global_load_dwordx4 v[208:211], v197, s[36:37] sc1
    s_waitcnt vmcnt(3)
    s_nop 0
    s_mov_b32 s74, 0x05040100
    s_mov_b32 s75, 0x07060302
    v_perm_b32 v156, v141, v140, s74
    v_perm_b32 v157, v141, v140, s75
    v_perm_b32 v158, v143, v142, s74
    v_perm_b32 v159, v143, v142, s75
    v_perm_b32 v160, v145, v144, s74
    v_perm_b32 v161, v145, v144, s75
    v_perm_b32 v162, v147, v146, s74
    v_perm_b32 v163, v147, v146, s75
    v_perm_b32 v164, v149, v148, s74
    v_perm_b32 v165, v149, v148, s75
    v_perm_b32 v166, v151, v150, s74
    v_perm_b32 v167, v151, v150, s75
    v_perm_b32 v168, v153, v152, s74
    v_perm_b32 v169, v153, v152, s75
    v_perm_b32 v170, v155, v154, s74
    v_perm_b32 v171, v155, v154, s75
    s_branch L_p_chk_9
L_p_7:
    global_load_dwordx4 v[204:207], v196, s[36:37] sc1
    global_load_dwordx4 v[208:211], v197, s[36:37] sc1
L_p_chk_9:
    s_waitcnt vmcnt(0)
    v_xor_b32 v204, s41, v204
    v_xor_b32 v205, s42, v205
    v_xor_b32 v206, s43, v206
    v_xor_b32 v207, s44, v207
    v_xor_b32 v208, s41, v208
    v_xor_b32 v209, s42, v209
    v_xor_b32 v210, s43, v210
    v_xor_b32 v211, s44, v211
    v_or3_b32 v56, v204, v205, v206
    v_or3_b32 v57, v207, v208, v209
    v_or3_b32 v56, v56, v210, v211
    v_or_b32_e64 v56, v56, v57
    v_and_b32 v56, 0xff, v56
    v_cmp_ne_u32 vcc, 0, v56
    s_cbranch_vccz L_p_done_8
    s_sub_u32 s45, s45, 1
    s_cbranch_scc1 L_p_done_8
    s_cmp_lg_u32 s45, 19992
    s_cbranch_scc1 L_r_pfb
    s_mov_b64 exec, 0xffff
    global_store_dwordx4 v193, v[226:229], s[36:37] sc1
    s_mov_b64 exec, -1
L_r_pfb:
    s_cmp_lg_u32 s45, 19988
    s_cbranch_scc1 L_r_psw
    v_subrev_u32 v196, 5046272, v196
    v_subrev_u32 v197, 5046272, v197
L_r_psw:
    s_sleep 1
    s_branch L_p_7
L_p_done_8:
    s_setprio 2
    v_pk_add_f32 v[204:205], v[204:205], v[208:209]
    v_pk_add_f32 v[206:207], v[206:207], v[210:211]
    s_nop 0
    v_permlane32_swap_b32 v204, v205
    v_permlane32_swap_b32 v206, v207
    v_add_f32 v204, v204, v205
    v_add_f32 v206, v206, v207
    v_mov_b32 v205, v204
    v_mov_b32 v207, v206
    s_nop 0
    v_permlane16_swap_b32 v204, v205
    v_permlane16_swap_b32 v206, v207
    v_add_f32 v40, v204, v205
    v_add_f32 v44, v206, v207
    v_cvt_pk_bf16_f32 v40, 0, v40
    v_mul_f32 v41, s66, v40
    v_exp_f32 v41, v41
    v_cvt_pk_bf16_f32 v44, 0, v44
    v_add_f32 v41, 1.0, v41
    v_rcp_f32 v41, v41
    s_nop 0
    v_mul_f32 v40, v40, v41
    v_cvt_pk_bf16_f32 v40, 0, v40
    v_mul_f32 v40, v40, v44
    s_nop 1
    v_mov_b32_dpp v41, v40 quad_perm:[1,0,3,2] row_mask:0xf bank_mask:0xf
    v_cvt_pk_bf16_f32 v40, v40, v41
    v_mov_b32 v41, v40
    v_mov_b32 v216, 0
    v_mov_b32 v217, 0
    v_permlane32_swap_b32 v40, v41
    v_mov_b32 v218, 0
    v_mov_b32 v219, 0
    v_dot2c_f32_bf16_dpp v216, v40, v156 row_newbcast:0 row_mask:0xf bank_mask:0xf
    v_dot2c_f32_bf16_dpp v217, v40, v157 row_newbcast:0 row_mask:0xf bank_mask:0xf
    v_dot2c_f32_bf16_dpp v218, v41, v156 row_newbcast:0 row_mask:0xf bank_mask:0xf
    v_dot2c_f32_bf16_dpp v219, v41, v157 row_newbcast:0 row_mask:0xf bank_mask:0xf
    v_dot2c_f32_bf16_dpp v216, v40, v158 row_newbcast:2 row_mask:0xf bank_mask:0xf
    v_dot2c_f32_bf16_dpp v217, v40, v159 row_newbcast:2 row_mask:0xf bank_mask:0xf
    v_dot2c_f32_bf16_dpp v218, v41, v158 row_newbcast:2 row_mask:0xf bank_mask:0xf
    v_dot2c_f32_bf16_dpp v219, v41, v159 row_newbcast:2 row_mask:0xf bank_mask:0xf
    v_dot2c_f32_bf16_dpp v216, v40, v160 row_newbcast:4 row_mask:0xf bank_mask:0xf
    v_dot2c_f32_bf16_dpp v217, v40, v161 row_newbcast:4 row_mask:0xf bank_mask:0xf
    v_dot2c_f32_bf16_dpp v218, v41, v160 row_newbcast:4 row_mask:0xf bank_mask:0xf
    v_dot2c_f32_bf16_dpp v219, v41, v161 row_newbcast:4 row_mask:0xf bank_mask:0xf
    v_dot2c_f32_bf16_dpp v216, v40, v162 row_newbcast:6 row_mask:0xf bank_mask:0xf
    v_dot2c_f32_bf16_dpp v217, v40, v163 row_newbcast:6 row_mask:0xf bank_mask:0xf
    v_dot2c_f32_bf16_dpp v218, v41, v162 row_newbcast:6 row_mask:0xf bank_mask:0xf
    v_dot2c_f32_bf16_dpp v219, v41, v163 row_newbcast:6 row_mask:0xf bank_mask:0xf
    v_dot2c_f32_bf16_dpp v216, v40, v164 row_newbcast:8 row_mask:0xf bank_mask:0xf
    v_dot2c_f32_bf16_dpp v217, v40, v165 row_newbcast:8 row_mask:0xf bank_mask:0xf
    v_dot2c_f32_bf16_dpp v218, v41, v164 row_newbcast:8 row_mask:0xf bank_mask:0xf
    v_dot2c_f32_bf16_dpp v219, v41, v165 row_newbcast:8 row_mask:0xf bank_mask:0xf
    v_dot2c_f32_bf16_dpp v216, v40, v166 row_newbcast:10 row_mask:0xf bank_mask:0xf
    v_dot2c_f32_bf16_dpp v217, v40, v167 row_newbcast:10 row_mask:0xf bank_mask:0xf
    v_dot2c_f32_bf16_dpp v218, v41, v166 row_newbcast:10 row_mask:0xf bank_mask:0xf
    v_dot2c_f32_bf16_dpp v219, v41, v167 row_newbcast:10 row_mask:0xf bank_mask:0xf
    v_dot2c_f32_bf16_dpp v216, v40, v168 row_newbcast:12 row_mask:0xf bank_mask:0xf
    v_dot2c_f32_bf16_dpp v217, v40, v169 row_newbcast:12 row_mask:0xf bank_mask:0xf
    v_dot2c_f32_bf16_dpp v218, v41, v168 row_newbcast:12 row_mask:0xf bank_mask:0xf
    v_dot2c_f32_bf16_dpp v219, v41, v169 row_newbcast:12 row_mask:0xf bank_mask:0xf
    v_dot2c_f32_bf16_dpp v216, v40, v170 row_newbcast:14 row_mask:0xf bank_mask:0xf
    v_dot2c_f32_bf16_dpp v217, v40, v171 row_newbcast:14 row_mask:0xf bank_mask:0xf
    v_dot2c_f32_bf16_dpp v218, v41, v170 row_newbcast:14 row_mask:0xf bank_mask:0xf
    v_dot2c_f32_bf16_dpp v219, v41, v171 row_newbcast:14 row_mask:0xf bank_mask:0xf
    v_and_or_b32 v216, v216, v203, s41
    v_and_or_b32 v217, v217, v203, s42
    v_and_or_b32 v218, v218, v203, s43
    v_and_or_b32 v219, v219, v203, s44
    global_store_dwordx4 v198, v[216:219], s[36:37] sc1
    s_mov_b64 exec, 0xffff
    global_store_dwordx4 v193, v[226:229], s[36:37] sc1
    s_mov_b64 exec, -1
    s_setprio 0
    s_branch L_r_know
L_r_nost2:
    s_setprio 0
    s_branch L_r_know
L_r_noffn:
    s_setprio 0
    s_mov_b32 s45, 20000
L_rec_10:
    global_load_dwordx4 v[204:207], v3, s[36:37] sc1
L_rec_chk_12:
    s_waitcnt vmcnt(0)
    v_cmp_ne_u32 vcc, s38, v207
    s_cbranch_vccz L_rec_done_11
    s_sub_u32 s45, s45, 1
    s_cbranch_scc1 L_rec_done_11
    s_sleep 8
    s_branch L_rec_10
L_rec_done_11:
    v_readfirstlane_b32 s70, v204
    s_nop 0
    s_lshr_b32 s71, s70, 16
    s_and_b32 s70, s70, 0xffff
L_r_know:
    s_cmp_ge_u32 s49, s54
    s_cbranch_scc1 L_r_dop
    s_cmp_ge_u32 s40, 2
    s_cbranch_scc1 L_r_pdone
L_r_dop:
    s_setprio 0
    s_setprio 0
L_r_pdone:
    s_mov_b32 s45, 20000
    global_load_dword v204, v244, s[36:37] sc1
    s_lshl_b32 s46, s39, 3
    v_lshl_add_u32 v7, v36, 2, s46
    v_cmp_ne_u32 vcc, s70, v7
    v_cmp_ne_u32 s[74:75], s71, v7
    s_nop 0
    s_and_b64 s[22:23], vcc, s[74:75]
    v_add_u32 v7, 1, v7
    v_cmp_ne_u32 vcc, s70, v7
    v_cmp_ne_u32 s[74:75], s71, v7
    s_nop 0
    s_and_b64 s[6:7], vcc, s[74:75]
    v_add_u32 v7, 1, v7
    v_cmp_ne_u32 vcc, s70, v7
    v_cmp_ne_u32 s[74:75], s71, v7
    s_nop 0
    s_and_b64 s[8:9], vcc, s[74:75]
    v_add_u32 v7, 1, v7
    v_cmp_ne_u32 vcc, s70, v7
    v_cmp_ne_u32 s[74:75], s71, v7
    s_nop 0
    s_and_b64 s[10:11], vcc, s[74:75]
    s_mov_b32 s46, 0xffff0000
    s_branch L_hu_chk_15
L_hu_13:
    global_load_dword v204, v244, s[36:37] sc1
L_hu_chk_15:
    s_waitcnt vmcnt(0)
    v_cmp_eq_u32 vcc, s38, v204
    s_nop 0
    s_cmp_eq_u64 vcc, 0
    s_cselect_b64 vcc, -1, 0
    s_cbranch_vccz L_hu_done_14
    s_sub_u32 s45, s45, 1
    s_cbranch_scc1 L_hu_done_14
    s_sleep 2
    s_branch L_hu_13
L_hu_done_14:
L_r_go:
    s_setprio 2
    s_mov_b32 s45, 20000
L_e2_16:
    global_load_dwordx4 v[76:79], v199, s[36:37] sc1
    global_load_dwordx4 v[80:83], v200, s[36:37] sc1
L_e2_chk_18:
    s_waitcnt vmcnt(0)
    v_max3_u32 v56, v76, v77, v78
    v_max3_u32 v57, v79, v80, v81
    v_max3_u32 v56, v56, v82, v83
    v_max_u32 v56, v56, v57
    v_cmp_eq_u32 vcc, -1, v56
    s_cbranch_vccz L_e2_done_17
    s_sub_u32 s45, s45, 1
    s_cbranch_scc1 L_e2_done_17
    s_mov_b64 exec, vcc
    s_sleep 1
    s_branch L_e2_16
L_e2_done_17:
    s_mov_b64 exec, -1
    v_lshlrev_b32 v40, 16, v76
    v_and_b32 v41, s46, v76
    v_lshlrev_b32 v48, 16, v80
    v_and_b32 v49, s46, v80
    v_pk_fma_f32 v[40:41], v[40:41], v[124:125], v[92:93]
    v_pk_fma_f32 v[48:49], v[48:49], v[132:133], v[100:101]
    v_cvt_pk_bf16_f32 v68, v40, v41
    v_cvt_pk_bf16_f32 v69, v48, v49
    s_mov_b64 exec, s[22:23]
    global_store_dwordx2 v34, v[68:69], s[32:33] offset:0
    s_mov_b64 exec, -1
    v_lshlrev_b32 v42, 16, v77
    v_and_b32 v43, s46, v77
    v_lshlrev_b32 v50, 16, v81
    v_and_b32 v51, s46, v81
    v_pk_fma_f32 v[42:43], v[42:43], v[126:127], v[94:95]
    v_pk_fma_f32 v[50:51], v[50:51], v[134:135], v[102:103]
    v_cvt_pk_bf16_f32 v70, v42, v43
    v_cvt_pk_bf16_f32 v71, v50, v51
    s_mov_b64 exec, s[6:7]
    global_store_dwordx2 v34, v[70:71], s[32:33] offset:1024
    s_mov_b64 exec, -1
    v_lshlrev_b32 v44, 16, v78
    v_and_b32 v45, s46, v78
    v_lshlrev_b32 v52, 16, v82
    v_and_b32 v53, s46, v82
    v_pk_fma_f32 v[44:45], v[44:45], v[128:129], v[96:97]
    v_pk_fma_f32 v[52:53], v[52:53], v[136:137], v[104:105]
    v_cvt_pk_bf16_f32 v72, v44, v45
    v_cvt_pk_bf16_f32 v73, v52, v53
    s_mov_b64 exec, s[8:9]
    global_store_dwordx2 v34, v[72:73], s[32:33] offset:2048
    s_mov_b64 exec, -1
    v_lshlrev_b32 v46, 16, v79
    v_and_b32 v47, s46, v79
    v_lshlrev_b32 v54, 16, v83
    v_and_b32 v55, s46, v83
    v_pk_fma_f32 v[46:47], v[46:47], v[130:131], v[98:99]
    v_pk_fma_f32 v[54:55], v[54:55], v[138:139], v[106:107]
    v_cvt_pk_bf16_f32 v74, v46, v47
    v_cvt_pk_bf16_f32 v75, v54, v55
    s_mov_b64 exec, s[10:11]
    global_store_dwordx2 v34, v[74:75], s[32:33] offset:3072
    s_mov_b64 exec, -1
    s_cmp_lg_u32 s39, 0
    s_cbranch_scc1 L_r_nogen
    s_barrier
    s_cmp_lg_u32 s40, 0
    s_cbranch_scc1 L_r_nogen
    s_mov_b64 exec, 1
    v_mov_b32 v38, 0
    v_mov_b32 v39, s38
    global_store_dword v38, v39, s[36:37]
    s_mov_b64 exec, -1
L_r_nogen:
    s_endpgm
L_conv:
    s_setprio 2
    s_lshr_b32 s58, s40, 1
    s_and_b32 s59, s40, 1
    s_mul_i32 s60, s58, 34816
    v_mul_u32_u24 v2, 272, v0
    s_mov_b32 s47, 1069066811
    s_lshl_b32 s45, s39, 13
    s_add_u32 s45, s45, 3149824
    v_lshl_add_u32 v231, v0, 4, s45
    v_and_b32 v5, 1, v0
    s_lshl_b32 s45, s39, 5
    s_add_u32 s45, s45, 1048576
    v_lshrrev_b32 v16, 1, v0
    v_lshlrev_b32 v56, 13, v16
    v_lshl_add_u32 v56, v5, 4, v56
    v_add_u32_e64 v56, s45, v56
    v_add_u32 v57, 0x100000, v56
    v_mul_u32_u24 v58, 4672, v5
    v_lshl_add_u32 v58, v16, 4, v58
    v_add_u32 v58, 70112, v58
    v_and_b32 v16, 15, v1
    v_lshrrev_b32 v17, 4, v1
    s_mul_i32 s45, s58, 4672
    s_lshl_b32 s46, s59, 8
    s_sub_u32 s45, s45, s46
    s_add_u32 s45, s45, 69888
    v_lshl_add_u32 v59, v16, 1, v17
    v_lshl_add_u32 v59, v59, 4, s45
    v_add_u32 v60, 1, v16
    v_lshrrev_b32 v60, 1, v60
    v_lshlrev_b32 v61, 2, v17
    v_sub_u32 v60, v61, v60
    v_lshlrev_b32_e64 v60, 2, v60
    v_mul_u32_u24 v61, 4160, v5
    v_sub_u32 v60, v60, v61
    s_sub_u32 s45, s60, s46
    s_add_u32 s45, s45, 7520
    v_add_u32_e64 v60, s45, v60
    v_subrev_u32 v61, 1024, v60
    v_subrev_u32 v62, 2048, v60
    v_subrev_u32 v63, 3072, v60
    v_lshl_add_u32 v228, v17, 2, v16
    v_and_b32_e64 v228, 15, v228
    v_lshl_add_u32 v228, v17, 4, v228
    s_lshl_b32 s45, s59, 13
    s_add_u32 s45, s45, s60
    s_add_u32 s45, s45, 8704
    v_lshl_add_u32 v228, v228, 4, s45
    v_lshrrev_b32 v16, 2, v1
    v_and_b32 v17, 3, v1
    v_lshl_add_u32 v229, v17, 2, v16
    v_and_b32_e64 v229, 15, v229
    v_lshl_add_u32 v229, v17, 4, v229
    s_lshl_b32 s45, s40, 10
    v_lshl_add_u32 v229, v229, 4, s45
    s_lshl_b32 s73, s48, 8
    s_add_u32 s73, s73, 196608
    v_mov_b32 v232, s73
    s_lshl_b32 s45, s39, 8
    s_add_u32 s45, s45, 5505024
    v_mov_b32 v244, s45
    v_lshrrev_b32 v16, 5, v1
    v_mul_u32_u24 v16, 4672, v16
    v_and_b32_e64 v17, 31, v1
    v_lshl_add_u32 v16, v17, 4, v16
    v_add_u32 v16, 69632, v16
    v_mov_b32 v224, 0
    v_mov_b32 v225, 0
    v_mov_b32 v226, 0
    v_mov_b32 v227, 0
    ds_write_b128 v16, v[224:227]
    v_bfe_u32 v16, v1, 2, 2
    v_lshlrev_b32 v16, 2, v16
    v_lshrrev_b32 v17, 5, v1
    v_lshl_add_u32 v16, v17, 1, v16
    v_mul_u32_u24 v16, 272, v16
    v_and_b32_e64 v17, 16, v1
    v_lshl_add_u32 v16, v17, 1, v16
    v_and_b32_e64 v17, 3, v1
    v_lshl_add_u32 v16, v17, 3, v16
    s_mul_i32 s61, s40, 17408
    v_add_u32 v234, s61, v16
    s_xor_b32 s62, s40, 1
    s_mul_i32 s62, s62, 17408
    v_add_u32 v240, s62, v16
    v_sub_u32 v16, 63, v1
    s_mul_i32 s45, s59, 4160
    s_add_u32 s45, s45, s60
    v_lshl_add_u32 v241, v16, 4, s45
    s_mov_b32 s62, 0xaaaaaaaa
    s_mov_b32 s63, 0xaaaaaaaa
    v_and_b32 v16, 15, v1
    v_lshrrev_b32_e64 v17, 4, v1
    s_mul_i32 s45, s59, 4162
    s_add_u32 s45, s45, s60
    s_add_u32 s45, s45, 62
    v_and_b32 v18, 62, v1
    v_sub_u32 v18, s45, v18
    v_lshl_add_u32 v236, v5, 8, v18
    v_add_u32 v18, 1, v16
    v_lshrrev_b32 v18, 1, v18
    v_lshlrev_b32 v19, 1, v17
    v_sub_u32 v18, v19, v18
    v_lshlrev_b32_e64 v18, 2, v18
    v_mul_u32_u24 v19, 4160, v5
    v_sub_u32 v18, v18, v19
    s_lshl_b32 s45, s59, 8
    s_add_u32 s45, s45, s60
    s_add_u32 s45, s45, 4192
    v_add_u32 v237, s45, v18
    s_mul_i32 s45, s59, 4160
    s_add_u32 s45, s45, s60
    s_add_u32 s45, s45, 128
    v_and_b32 v18, 2, v1
    v_lshlrev_b32_e64 v18, 3, v18
    v_lshl_add_u32 v18, v5, 8, v18
    v_add_u32 v238, s45, v18
    s_waitcnt vmcnt(0)
    v_lshlrev_b32 v8, 16, v8
    v_lshlrev_b32 v9, 16, v9
    v_lshlrev_b32 v10, 16, v10
    v_lshlrev_b32 v11, 16, v11
    v_lshlrev_b32 v12, 16, v12
    v_lshlrev_b32 v13, 16, v13
    v_lshlrev_b32 v14, 16, v14
    v_mul_f32 v14, s47, v14
    v_exp_f32 v14, v14
    s_nop 0
    v_cvt_pk_bf16_f32 v14, 0, v14
    v_mul_f32 v8, v14, v8
    v_mul_f32 v9, v14, v9
    v_mul_f32 v14, 0x41800000, v14
    v_mul_f32 v8, s47, v8
    v_mul_f32 v9, 0.15915494, v9
    v_mul_f32 v10, v14, v10
    v_mul_f32 v11, v14, v11
    v_fract_f32 v17, v9
    v_exp_f32 v16, v8
    v_cos_f32 v64, v17
    v_sin_f32 v65, v17
    s_nop 0
    v_pk_mul_f32 v[64:65], v[64:65], v[16:17] op_sel_hi:[1,0]
    v_mul_f32 v16, 0x41000000, v8
    v_mul_f32 v17, 0x41000000, v9
    v_fract_f32 v17, v17
    v_exp_f32 v16, v16
    v_cos_f32 v66, v17
    v_sin_f32 v67, v17
    s_nop 0
    v_pk_mul_f32 v[66:67], v[66:67], v[16:17] op_sel_hi:[1,0]
    v_mul_f32 v16, 0x43800000, v8
    v_mul_f32 v17, 0x43800000, v9
    v_fract_f32 v17, v17
    v_exp_f32 v16, v16
    v_cos_f32 v68, v17
    v_sin_f32 v69, v17
    s_nop 0
    s_nop 0
    v_pk_mul_f32 v[68:69], v[68:69], v[16:17] op_sel_hi:[1,0]
    v_pk_mul_f32 v[72:73], v[12:13], v[10:11] op_sel_hi:[0,1]
    v_pk_fma_f32 v[70:71], v[12:13], v[10:11], v[72:73] op_sel:[1,1,0] op_sel_hi:[1,0,1] neg_lo:[1,0,0]
    v_pk_mul_f32 v[74:75], v[66:67], v[66:67] op_sel_hi:[0,1]
    v_pk_fma_f32 v[80:81], v[66:67], v[66:67], v[74:75] op_sel:[1,1,0] op_sel_hi:[1,0,1] neg_lo:[1,0,0]
    v_pk_mul_f32 v[76:77], v[80:81], v[66:67] op_sel_hi:[0,1]
    v_pk_fma_f32 v[82:83], v[80:81], v[66:67], v[76:77] op_sel:[1,1,0] op_sel_hi:[1,0,1] neg_lo:[1,0,0]
    v_pk_mul_f32 v[78:79], v[80:81], v[80:81] op_sel_hi:[0,1]
    v_pk_fma_f32 v[84:85], v[80:81], v[80:81], v[78:79] op_sel:[1,1,0] op_sel_hi:[1,0,1] neg_lo:[1,0,0]
    v_cvt_pk_bf16_f32 v16, 1.0, v66
    v_cvt_pk_bf16_f32 v20, 0, v67
    v_cvt_pk_bf16_f32 v17, v80, v82
    v_cvt_pk_bf16_f32 v21, v81, v83
    v_pk_mul_f32 v[72:73], v[70:71], v[64:65] op_sel_hi:[0,1]
    v_pk_fma_f32 v[98:99], v[70:71], v[64:65], v[72:73] op_sel:[1,1,0] op_sel_hi:[1,0,1] neg_lo:[1,0,0]
    v_pk_mul_f32 v[74:75], v[66:67], v[84:85] op_sel_hi:[0,1]
    v_pk_fma_f32 v[92:93], v[66:67], v[84:85], v[74:75] op_sel:[1,1,0] op_sel_hi:[1,0,1] neg_lo:[1,0,0]
    v_cvt_pk_bf16_f32 v18, v84, v92
    v_cvt_pk_bf16_f32 v22, v85, v93
    v_pk_mul_f32 v[76:77], v[98:99], v[64:65] op_sel_hi:[0,1]
    v_pk_fma_f32 v[100:101], v[98:99], v[64:65], v[76:77] op_sel:[1,1,0] op_sel_hi:[1,0,1] neg_lo:[1,0,0]
    v_pk_mul_f32 v[78:79], v[80:81], v[84:85] op_sel_hi:[0,1]
    v_pk_fma_f32 v[94:95], v[80:81], v[84:85], v[78:79] op_sel:[1,1,0] op_sel_hi:[1,0,1] neg_lo:[1,0,0]
    v_pk_mul_f32 v[72:73], v[100:101], v[64:65] op_sel_hi:[0,1]
    v_pk_fma_f32 v[102:103], v[100:101], v[64:65], v[72:73] op_sel:[1,1,0] op_sel_hi:[1,0,1] neg_lo:[1,0,0]
    v_pk_mul_f32 v[74:75], v[82:83], v[84:85] op_sel_hi:[0,1]
    v_pk_fma_f32 v[96:97], v[82:83], v[84:85], v[74:75] op_sel:[1,1,0] op_sel_hi:[1,0,1] neg_lo:[1,0,0]
    v_cvt_pk_bf16_f32 v19, v94, v96
    v_cvt_pk_bf16_f32 v23, v95, v97
    ds_write_b128 v2, v[16:19] offset:128
    v_pk_mul_f32 v[76:77], v[102:103], v[64:65] op_sel_hi:[0,1]
    v_pk_fma_f32 v[104:105], v[102:103], v[64:65], v[76:77] op_sel:[1,1,0] op_sel_hi:[1,0,1] neg_lo:[1,0,0]
    ds_write_b128 v2, v[20:23] offset:192
    v_pk_mul_f32 v[78:79], v[84:85], v[84:85] op_sel_hi:[0,1]
    v_pk_fma_f32 v[90:91], v[84:85], v[84:85], v[78:79] op_sel:[1,1,0] op_sel_hi:[1,0,1] neg_lo:[1,0,0]
    v_pk_mul_f32 v[72:73], v[70:71], v[68:69] op_sel_hi:[0,1]
    v_pk_fma_f32 v[106:107], v[70:71], v[68:69], v[72:73] op_sel:[1,1,0] op_sel_hi:[1,0,1] neg_lo:[1,0,0]
    v_pk_mul_f32 v[74:75], v[92:93], v[84:85] op_sel_hi:[0,1]
    v_pk_fma_f32 v[92:93], v[92:93], v[84:85], v[74:75] op_sel:[1,1,0] op_sel_hi:[1,0,1] neg_lo:[1,0,0]
    v_cvt_pk_bf16_f32 v24, v90, v92
    v_cvt_pk_bf16_f32 v28, v91, v93
    v_pk_mul_f32 v[76:77], v[100:101], v[68:69] op_sel_hi:[0,1]
    v_pk_fma_f32 v[108:109], v[100:101], v[68:69], v[76:77] op_sel:[1,1,0] op_sel_hi:[1,0,1] neg_lo:[1,0,0]
    v_pk_mul_f32 v[78:79], v[94:95], v[84:85] op_sel_hi:[0,1]
    v_pk_fma_f32 v[94:95], v[94:95], v[84:85], v[78:79] op_sel:[1,1,0] op_sel_hi:[1,0,1] neg_lo:[1,0,0]
    v_pk_mul_f32 v[72:73], v[104:105], v[68:69] op_sel_hi:[0,1]
    v_pk_fma_f32 v[110:111], v[104:105], v[68:69], v[72:73] op_sel:[1,1,0] op_sel_hi:[1,0,1] neg_lo:[1,0,0]
    v_pk_mul_f32 v[74:75], v[96:97], v[84:85] op_sel_hi:[0,1]
    v_pk_fma_f32 v[96:97], v[96:97], v[84:85], v[74:75] op_sel:[1,1,0] op_sel_hi:[1,0,1] neg_lo:[1,0,0]
    v_cvt_pk_bf16_f32 v25, v94, v96
    v_cvt_pk_bf16_f32 v29, v95, v97
    v_cvt_pk_bf16_f32 v32, v70, v98
    v_cvt_pk_bf16_f32 v33, v100, v102
    v_cvt_pk_bf16_f32 v34, v106, v106
    v_cvt_pk_bf16_f32 v35, v108, v110
    ds_write_b128 v2, v[32:35] offset:0
    v_cvt_pk_bf16_f32 v36, -v71, -v99
    v_cvt_pk_bf16_f32 v37, -v101, -v103
    v_cvt_pk_bf16_f32 v38, -v107, -v107
    v_cvt_pk_bf16_f32 v39, -v109, -v111
    ds_write_b128 v2, v[36:39] offset:64
    v_pk_mul_f32 v[76:77], v[68:69], v[68:69] op_sel_hi:[0,1]
    v_pk_fma_f32 v[86:87], v[68:69], v[68:69], v[76:77] op_sel:[1,1,0] op_sel_hi:[1,0,1] neg_lo:[1,0,0]
    v_pk_mul_f32 v[78:79], v[90:91], v[84:85] op_sel_hi:[0,1]
    v_pk_fma_f32 v[90:91], v[90:91], v[84:85], v[78:79] op_sel:[1,1,0] op_sel_hi:[1,0,1] neg_lo:[1,0,0]
    v_pk_mul_f32 v[72:73], v[104:105], v[64:65] op_sel_hi:[0,1]
    v_pk_fma_f32 v[112:113], v[104:105], v[64:65], v[72:73] op_sel:[1,1,0] op_sel_hi:[1,0,1] neg_lo:[1,0,0]
    v_pk_mul_f32 v[74:75], v[92:93], v[84:85] op_sel_hi:[0,1]
    v_pk_fma_f32 v[92:93], v[92:93], v[84:85], v[74:75] op_sel:[1,1,0] op_sel_hi:[1,0,1] neg_lo:[1,0,0]
    v_cvt_pk_bf16_f32 v26, v90, v92
    v_cvt_pk_bf16_f32 v30, v91, v93
    v_pk_mul_f32 v[76:77], v[112:113], v[64:65] op_sel_hi:[0,1]
    v_pk_fma_f32 v[114:115], v[112:113], v[64:65], v[76:77] op_sel:[1,1,0] op_sel_hi:[1,0,1] neg_lo:[1,0,0]
    v_pk_mul_f32 v[78:79], v[94:95], v[84:85] op_sel_hi:[0,1]
    v_pk_fma_f32 v[94:95], v[94:95], v[84:85], v[78:79] op_sel:[1,1,0] op_sel_hi:[1,0,1] neg_lo:[1,0,0]
    v_pk_mul_f32 v[72:73], v[114:115], v[64:65] op_sel_hi:[0,1]
    v_pk_fma_f32 v[116:117], v[114:115], v[64:65], v[72:73] op_sel:[1,1,0] op_sel_hi:[1,0,1] neg_lo:[1,0,0]
    v_pk_mul_f32 v[74:75], v[96:97], v[84:85] op_sel_hi:[0,1]
    v_pk_fma_f32 v[96:97], v[96:97], v[84:85], v[74:75] op_sel:[1,1,0] op_sel_hi:[1,0,1] neg_lo:[1,0,0]
    v_cvt_pk_bf16_f32 v27, v94, v96
    v_cvt_pk_bf16_f32 v31, v95, v97
    ds_write_b128 v2, v[24:27] offset:144
    v_pk_mul_f32 v[76:77], v[116:117], v[64:65] op_sel_hi:[0,1]
    v_pk_fma_f32 v[118:119], v[116:117], v[64:65], v[76:77] op_sel:[1,1,0] op_sel_hi:[1,0,1] neg_lo:[1,0,0]
    ds_write_b128 v2, v[28:31] offset:208
    v_pk_mul_f32 v[78:79], v[90:91], v[84:85] op_sel_hi:[0,1]
    v_pk_fma_f32 v[90:91], v[90:91], v[84:85], v[78:79] op_sel:[1,1,0] op_sel_hi:[1,0,1] neg_lo:[1,0,0]
    v_pk_mul_f32 v[72:73], v[114:115], v[68:69] op_sel_hi:[0,1]
    v_pk_fma_f32 v[120:121], v[114:115], v[68:69], v[72:73] op_sel:[1,1,0] op_sel_hi:[1,0,1] neg_lo:[1,0,0]
    v_pk_mul_f32 v[74:75], v[92:93], v[84:85] op_sel_hi:[0,1]
    v_pk_fma_f32 v[92:93], v[92:93], v[84:85], v[74:75] op_sel:[1,1,0] op_sel_hi:[1,0,1] neg_lo:[1,0,0]
    v_cvt_pk_bf16_f32 v40, v90, v92
    v_cvt_pk_bf16_f32 v44, v91, v93
    v_pk_mul_f32 v[76:77], v[118:119], v[68:69] op_sel_hi:[0,1]
    v_pk_fma_f32 v[122:123], v[118:119], v[68:69], v[76:77] op_sel:[1,1,0] op_sel_hi:[1,0,1] neg_lo:[1,0,0]
    v_pk_mul_f32 v[78:79], v[94:95], v[84:85] op_sel_hi:[0,1]
    v_pk_fma_f32 v[94:95], v[94:95], v[84:85], v[78:79] op_sel:[1,1,0] op_sel_hi:[1,0,1] neg_lo:[1,0,0]
    v_cvt_pk_bf16_f32 v16, v104, v112
    v_cvt_pk_bf16_f32 v17, v114, v116
    v_cvt_pk_bf16_f32 v18, v110, v110
    v_cvt_pk_bf16_f32 v19, v120, v122
    ds_write_b128 v2, v[16:19] offset:16
    v_cvt_pk_bf16_f32 v20, -v105, -v113
    v_cvt_pk_bf16_f32 v21, -v115, -v117
    v_cvt_pk_bf16_f32 v22, -v111, -v111
    v_cvt_pk_bf16_f32 v23, -v121, -v123
    ds_write_b128 v2, v[20:23] offset:80
    v_pk_mul_f32 v[72:73], v[86:87], v[86:87] op_sel_hi:[0,1]
    v_pk_fma_f32 v[88:89], v[86:87], v[86:87], v[72:73] op_sel:[1,1,0] op_sel_hi:[1,0,1] neg_lo:[1,0,0]
    v_pk_mul_f32 v[74:75], v[96:97], v[84:85] op_sel_hi:[0,1]
    v_pk_fma_f32 v[96:97], v[96:97], v[84:85], v[74:75] op_sel:[1,1,0] op_sel_hi:[1,0,1] neg_lo:[1,0,0]
    v_cvt_pk_bf16_f32 v41, v94, v96
    v_cvt_pk_bf16_f32 v45, v95, v97
    v_pk_mul_f32 v[76:77], v[70:71], v[86:87] op_sel_hi:[0,1]
    v_pk_fma_f32 v[124:125], v[70:71], v[86:87], v[76:77] op_sel:[1,1,0] op_sel_hi:[1,0,1] neg_lo:[1,0,0]
    v_pk_mul_f32 v[78:79], v[90:91], v[84:85] op_sel_hi:[0,1]
    v_pk_fma_f32 v[90:91], v[90:91], v[84:85], v[78:79] op_sel:[1,1,0] op_sel_hi:[1,0,1] neg_lo:[1,0,0]
    v_pk_mul_f32 v[72:73], v[104:105], v[86:87] op_sel_hi:[0,1]
    v_pk_fma_f32 v[126:127], v[104:105], v[86:87], v[72:73] op_sel:[1,1,0] op_sel_hi:[1,0,1] neg_lo:[1,0,0]
    v_pk_mul_f32 v[74:75], v[92:93], v[84:85] op_sel_hi:[0,1]
    v_pk_fma_f32 v[92:93], v[92:93], v[84:85], v[74:75] op_sel:[1,1,0] op_sel_hi:[1,0,1] neg_lo:[1,0,0]
    v_cvt_pk_bf16_f32 v42, v90, v92
    v_cvt_pk_bf16_f32 v46, v91, v93
    v_pk_mul_f32 v[76:77], v[118:119], v[86:87] op_sel_hi:[0,1]
    v_pk_fma_f32 v[128:129], v[118:119], v[86:87], v[76:77] op_sel:[1,1,0] op_sel_hi:[1,0,1] neg_lo:[1,0,0]
    v_pk_mul_f32 v[78:79], v[94:95], v[84:85] op_sel_hi:[0,1]
    v_pk_fma_f32 v[94:95], v[94:95], v[84:85], v[78:79] op_sel:[1,1,0] op_sel_hi:[1,0,1] neg_lo:[1,0,0]
    v_pk_mul_f32 v[72:73], v[106:107], v[86:87] op_sel_hi:[0,1]
    v_pk_fma_f32 v[130:131], v[106:107], v[86:87], v[72:73] op_sel:[1,1,0] op_sel_hi:[1,0,1] neg_lo:[1,0,0]
    v_pk_mul_f32 v[74:75], v[96:97], v[84:85] op_sel_hi:[0,1]
    v_pk_fma_f32 v[96:97], v[96:97], v[84:85], v[74:75] op_sel:[1,1,0] op_sel_hi:[1,0,1] neg_lo:[1,0,0]
    v_cvt_pk_bf16_f32 v43, v94, v96
    v_cvt_pk_bf16_f32 v47, v95, v97
    ds_write_b128 v2, v[40:43] offset:160
    v_pk_mul_f32 v[76:77], v[110:111], v[86:87] op_sel_hi:[0,1]
    v_pk_fma_f32 v[132:133], v[110:111], v[86:87], v[76:77] op_sel:[1,1,0] op_sel_hi:[1,0,1] neg_lo:[1,0,0]
    ds_write_b128 v2, v[44:47] offset:224
    v_pk_mul_f32 v[78:79], v[90:91], v[84:85] op_sel_hi:[0,1]
    v_pk_fma_f32 v[90:91], v[90:91], v[84:85], v[78:79] op_sel:[1,1,0] op_sel_hi:[1,0,1] neg_lo:[1,0,0]
    v_pk_mul_f32 v[72:73], v[122:123], v[86:87] op_sel_hi:[0,1]
    v_pk_fma_f32 v[134:135], v[122:123], v[86:87], v[72:73] op_sel:[1,1,0] op_sel_hi:[1,0,1] neg_lo:[1,0,0]
    v_pk_mul_f32 v[74:75], v[92:93], v[84:85] op_sel_hi:[0,1]
    v_pk_fma_f32 v[92:93], v[92:93], v[84:85], v[74:75] op_sel:[1,1,0] op_sel_hi:[1,0,1] neg_lo:[1,0,0]
    v_cvt_pk_bf16_f32 v24, v90, v92
    v_cvt_pk_bf16_f32 v28, v91, v93
    v_cvt_pk_bf16_f32 v32, v118, v124
    v_cvt_pk_bf16_f32 v33, v126, v128
    v_cvt_pk_bf16_f32 v34, v122, v130
    v_cvt_pk_bf16_f32 v35, v132, v134
    ds_write_b128 v2, v[32:35] offset:32
    v_cvt_pk_bf16_f32 v36, -v119, -v125
    v_cvt_pk_bf16_f32 v37, -v127, -v129
    v_cvt_pk_bf16_f32 v38, -v123, -v131
    v_cvt_pk_bf16_f32 v39, -v133, -v135
    ds_write_b128 v2, v[36:39] offset:96
    v_pk_mul_f32 v[76:77], v[70:71], v[88:89] op_sel_hi:[0,1]
    v_pk_fma_f32 v[136:137], v[70:71], v[88:89], v[76:77] op_sel:[1,1,0] op_sel_hi:[1,0,1] neg_lo:[1,0,0]
    v_pk_mul_f32 v[78:79], v[94:95], v[84:85] op_sel_hi:[0,1]
    v_pk_fma_f32 v[94:95], v[94:95], v[84:85], v[78:79] op_sel:[1,1,0] op_sel_hi:[1,0,1] neg_lo:[1,0,0]
    v_pk_mul_f32 v[72:73], v[118:119], v[88:89] op_sel_hi:[0,1]
    v_pk_fma_f32 v[138:139], v[118:119], v[88:89], v[72:73] op_sel:[1,1,0] op_sel_hi:[1,0,1] neg_lo:[1,0,0]
    v_pk_mul_f32 v[74:75], v[96:97], v[84:85] op_sel_hi:[0,1]
    v_pk_fma_f32 v[96:97], v[96:97], v[84:85], v[74:75] op_sel:[1,1,0] op_sel_hi:[1,0,1] neg_lo:[1,0,0]
    v_cvt_pk_bf16_f32 v25, v94, v96
    v_cvt_pk_bf16_f32 v29, v95, v97
    v_pk_mul_f32 v[76:77], v[122:123], v[88:89] op_sel_hi:[0,1]
    v_pk_fma_f32 v[140:141], v[122:123], v[88:89], v[76:77] op_sel:[1,1,0] op_sel_hi:[1,0,1] neg_lo:[1,0,0]
    v_pk_mul_f32 v[78:79], v[90:91], v[84:85] op_sel_hi:[0,1]
    v_pk_fma_f32 v[90:91], v[90:91], v[84:85], v[78:79] op_sel:[1,1,0] op_sel_hi:[1,0,1] neg_lo:[1,0,0]
    v_pk_mul_f32 v[72:73], v[128:129], v[88:89] op_sel_hi:[0,1]
    v_pk_fma_f32 v[142:143], v[128:129], v[88:89], v[72:73] op_sel:[1,1,0] op_sel_hi:[1,0,1] neg_lo:[1,0,0]
    v_pk_mul_f32 v[74:75], v[92:93], v[84:85] op_sel_hi:[0,1]
    v_pk_fma_f32 v[92:93], v[92:93], v[84:85], v[74:75] op_sel:[1,1,0] op_sel_hi:[1,0,1] neg_lo:[1,0,0]
    v_cvt_pk_bf16_f32 v26, v90, v92
    v_cvt_pk_bf16_f32 v30, v91, v93
    v_pk_mul_f32 v[76:77], v[134:135], v[88:89] op_sel_hi:[0,1]
    v_pk_fma_f32 v[144:145], v[134:135], v[88:89], v[76:77] op_sel:[1,1,0] op_sel_hi:[1,0,1] neg_lo:[1,0,0]
    v_pk_mul_f32 v[78:79], v[94:95], v[84:85] op_sel_hi:[0,1]
    v_pk_fma_f32 v[94:95], v[94:95], v[84:85], v[78:79] op_sel:[1,1,0] op_sel_hi:[1,0,1] neg_lo:[1,0,0]
    v_cvt_pk_bf16_f32 v40, v136, v138
    v_cvt_pk_bf16_f32 v41, v142, v142
    v_cvt_pk_bf16_f32 v42, v140, v140
    v_cvt_pk_bf16_f32 v43, v144, v144
    ds_write_b128 v2, v[40:43] offset:48
    v_cvt_pk_bf16_f32 v44, -v137, -v139
    v_cvt_pk_bf16_f32 v45, -v143, -v143
    v_cvt_pk_bf16_f32 v46, -v141, -v141
    v_cvt_pk_bf16_f32 v47, -v145, -v145
    ds_write_b128 v2, v[44:47] offset:112
    v_pk_mul_f32 v[72:73], v[96:97], v[84:85] op_sel_hi:[0,1]
    v_pk_fma_f32 v[96:97], v[96:97], v[84:85], v[72:73] op_sel:[1,1,0] op_sel_hi:[1,0,1] neg_lo:[1,0,0]
    v_cvt_pk_bf16_f32 v27, v94, v96
    v_cvt_pk_bf16_f32 v31, v95, v97
    ds_write_b128 v2, v[24:27] offset:176
    ds_write_b128 v2, v[28:31] offset:240
    s_waitcnt lgkmcnt(0)
    s_nop 0
    ds_read_b64_tr_b16 v[64:65], v234 offset:0
    ds_read_b64_tr_b16 v[66:67], v234 offset:272
    ds_read_b64_tr_b16 v[68:69], v234 offset:128
    ds_read_b64_tr_b16 v[70:71], v234 offset:400
    ds_read_b64_tr_b16 v[72:73], v234 offset:64
    ds_read_b64_tr_b16 v[74:75], v234 offset:336
    ds_read_b64_tr_b16 v[76:77], v234 offset:192
    ds_read_b64_tr_b16 v[78:79], v234 offset:464
    ds_read_b64_tr_b16 v[80:81], v234 offset:4352
    ds_read_b64_tr_b16 v[82:83], v234 offset:4624
    ds_read_b64_tr_b16 v[84:85], v234 offset:4480
    ds_read_b64_tr_b16 v[86:87], v234 offset:4752
    s_mul_i32 s45, s38, 1664525
    s_add_u32 s45, s45, 1013904223
    s_andn2_b32 s45, s45, 0x10001001
    s_andn2_b32 s38, 0x10001001, s38
    s_or_b32 s38, s38, s45
    s_and_b32 s41, s38, 0x70007000
    s_and_b32 s45, s38, 0x10001000
    s_lshl_b32 s42, s38, 3
    s_and_b32 s42, s42, 0x60006000
    s_or_b32 s42, s42, s45
    s_lshl_b32 s43, s38, 6
    s_and_b32 s43, s43, 0x60006000
    s_or_b32 s43, s43, s45
    s_lshl_b32 s44, s38, 9
    s_and_b32 s44, s44, 0x60006000
    s_or_b32 s44, s44, s45
    v_mov_b32 v242, s38
    v_mov_b32 v209, 0
    v_mov_b32 v210, 0
    v_mov_b32 v211, 0
    s_waitcnt lgkmcnt(8)
    v_mfma_f32_32x32x16_bf16 v[16:31], v[64:67], v[68:71], 0
    ds_read_b64_tr_b16 v[88:89], v234 offset:4416
    ds_read_b64_tr_b16 v[90:91], v234 offset:4688
    ds_read_b64_tr_b16 v[92:93], v234 offset:4544
    ds_read_b64_tr_b16 v[94:95], v234 offset:4816
    s_waitcnt lgkmcnt(8)
    v_mfma_f32_32x32x16_bf16 v[16:31], v[72:75], v[76:79], v[16:31]
    ds_read_b64_tr_b16 v[96:97], v234 offset:8704
    ds_read_b64_tr_b16 v[98:99], v234 offset:8976
    ds_read_b64_tr_b16 v[100:101], v234 offset:8832
    ds_read_b64_tr_b16 v[102:103], v234 offset:9104
    s_waitcnt lgkmcnt(8)
    v_mfma_f32_32x32x16_bf16 v[16:31], v[80:83], v[84:87], v[16:31]
    ds_read_b64_tr_b16 v[104:105], v234 offset:8768
    ds_read_b64_tr_b16 v[106:107], v234 offset:9040
    ds_read_b64_tr_b16 v[108:109], v234 offset:8896
    ds_read_b64_tr_b16 v[110:111], v234 offset:9168
    s_waitcnt lgkmcnt(8)
    v_mfma_f32_32x32x16_bf16 v[16:31], v[88:91], v[92:95], v[16:31]
    ds_read_b64_tr_b16 v[112:113], v234 offset:13056
    ds_read_b64_tr_b16 v[114:115], v234 offset:13328
    ds_read_b64_tr_b16 v[116:117], v234 offset:13184
    ds_read_b64_tr_b16 v[118:119], v234 offset:13456
    s_waitcnt lgkmcnt(8)
    v_mfma_f32_32x32x16_bf16 v[16:31], v[96:99], v[100:103], v[16:31]
    ds_read_b64_tr_b16 v[120:121], v234 offset:13120
    ds_read_b64_tr_b16 v[122:123], v234 offset:13392
    ds_read_b64_tr_b16 v[124:125], v234 offset:13248
    ds_read_b64_tr_b16 v[126:127], v234 offset:13520
    s_waitcnt lgkmcnt(8)
    v_mfma_f32_32x32x16_bf16 v[16:31], v[104:107], v[108:111], v[16:31]
    s_barrier
    ds_read_b64_tr_b16 v[128:129], v240 offset:0
    ds_read_b64_tr_b16 v[130:131], v240 offset:272
    ds_read_b64_tr_b16 v[132:133], v240 offset:128
    ds_read_b64_tr_b16 v[134:135], v240 offset:400
    s_waitcnt lgkmcnt(8)
    v_mfma_f32_32x32x16_bf16 v[16:31], v[112:115], v[116:119], v[16:31]
    ds_read_b64_tr_b16 v[136:137], v240 offset:64
    ds_read_b64_tr_b16 v[138:139], v240 offset:336
    ds_read_b64_tr_b16 v[140:141], v240 offset:192
    ds_read_b64_tr_b16 v[142:143], v240 offset:464
    s_waitcnt lgkmcnt(8)
    v_mfma_f32_32x32x16_bf16 v[16:31], v[120:123], v[124:127], v[16:31]
    ds_read_b64_tr_b16 v[144:145], v240 offset:4352
    ds_read_b64_tr_b16 v[146:147], v240 offset:4624
    ds_read_b64_tr_b16 v[148:149], v240 offset:4480
    ds_read_b64_tr_b16 v[150:151], v240 offset:4752
    s_waitcnt lgkmcnt(8)
    v_mfma_f32_32x32x16_bf16 v[16:31], v[128:131], v[132:135], v[16:31]
    ds_read_b64_tr_b16 v[152:153], v240 offset:4416
    ds_read_b64_tr_b16 v[154:155], v240 offset:4688
    ds_read_b64_tr_b16 v[156:157], v240 offset:4544
    ds_read_b64_tr_b16 v[158:159], v240 offset:4816
    s_waitcnt lgkmcnt(8)
    v_mfma_f32_32x32x16_bf16 v[16:31], v[136:139], v[140:143], v[16:31]
    ds_read_b64_tr_b16 v[160:161], v240 offset:8704
    ds_read_b64_tr_b16 v[162:163], v240 offset:8976
    ds_read_b64_tr_b16 v[164:165], v240 offset:8832
    ds_read_b64_tr_b16 v[166:167], v240 offset:9104
    s_waitcnt lgkmcnt(8)
    v_mfma_f32_32x32x16_bf16 v[16:31], v[144:147], v[148:151], v[16:31]
    ds_read_b64_tr_b16 v[168:169], v240 offset:8768
    ds_read_b64_tr_b16 v[170:171], v240 offset:9040
    ds_read_b64_tr_b16 v[172:173], v240 offset:8896
    ds_read_b64_tr_b16 v[174:175], v240 offset:9168
    s_waitcnt lgkmcnt(8)
    v_mfma_f32_32x32x16_bf16 v[16:31], v[152:155], v[156:159], v[16:31]
    ds_read_b64_tr_b16 v[176:177], v240 offset:13056
    ds_read_b64_tr_b16 v[178:179], v240 offset:13328
    ds_read_b64_tr_b16 v[180:181], v240 offset:13184
    ds_read_b64_tr_b16 v[182:183], v240 offset:13456
    s_waitcnt lgkmcnt(8)
    v_mfma_f32_32x32x16_bf16 v[16:31], v[160:163], v[164:167], v[16:31]
    ds_read_b64_tr_b16 v[184:185], v240 offset:13120
    ds_read_b64_tr_b16 v[186:187], v240 offset:13392
    ds_read_b64_tr_b16 v[188:189], v240 offset:13248
    ds_read_b64_tr_b16 v[190:191], v240 offset:13520
    s_waitcnt lgkmcnt(8)
    v_mfma_f32_32x32x16_bf16 v[16:31], v[168:171], v[172:175], v[16:31]
    s_waitcnt lgkmcnt(0)
    s_barrier
    v_mfma_f32_32x32x16_bf16 v[16:31], v[176:179], v[180:183], v[16:31]
    s_mov_b64 exec, 1
    ds_write_b128 v241, v[224:227] offset:3104
    s_mov_b64 exec, -1
    ds_write_b128 v238, v[224:227]
    s_mov_b64 s[74:75], 1
    v_mfma_f32_32x32x16_bf16 v[16:31], v[184:187], v[188:191], v[16:31]
    s_nop 11
    v_cvt_pk_bf16_f32 v33, v29, v31
    v_cndmask_b32 v32, 0, v28, s[74:75]
    ds_write_b16 v236, v33 offset:64
    ds_write_b16_d16_hi v236, v33
    s_cmp_lg_u32 s59, 0
    s_cbranch_scc1 L_c_odd
    v_cvt_pk_bf16_f32 v192, v23, v22
    v_cvt_pk_bf16_f32 v193, v21, v20
    v_cvt_pk_bf16_f32 v194, v19, v18
    v_cvt_pk_bf16_f32 v195, v17, v16
    ds_write_b128 v241, v[192:195] offset:3072
    v_cvt_pk_bf16_f32 v196, v27, v27
    v_cvt_pk_bf16_f32 v197, v26, v26
    v_cvt_pk_bf16_f32 v198, v26, v25
    v_cvt_pk_bf16_f32 v199, v25, v25
    ds_write_b128 v241, v[196:199] offset:2048
    v_cvt_pk_bf16_f32 v200, v224, v224
    v_cvt_pk_bf16_f32 v201, v224, v32
    v_cvt_pk_bf16_f32 v202, v32, v32
    v_cvt_pk_bf16_f32 v203, v32, v32
    ds_write_b128 v241, v[200:203] offset:1024
    v_mov_b32 v208, 0
    s_branch L_c_k
L_c_odd:
    v_cvt_pk_bf16_f32 v192, v24, v23
    v_cvt_pk_bf16_f32 v193, v22, v21
    v_cvt_pk_bf16_f32 v194, v20, v19
    v_cvt_pk_bf16_f32 v195, v18, v17
    ds_write_b128 v241, v[192:195] offset:3072
    v_cvt_pk_bf16_f32 v196, v27, v27
    v_cvt_pk_bf16_f32 v197, v27, v26
    v_cvt_pk_bf16_f32 v198, v26, v26
    v_cvt_pk_bf16_f32 v199, v25, v25
    ds_write_b128 v241, v[196:199] offset:2048
    v_cvt_pk_bf16_f32 v200, v224, v224
    v_cvt_pk_bf16_f32 v201, v224, v224
    v_cvt_pk_bf16_f32 v202, v32, v32
    v_cvt_pk_bf16_f32 v203, v32, v32
    ds_write_b128 v241, v[200:203] offset:1024
    v_cvt_pk_bf16_f32 v208, v16, 0
L_c_k:
    s_mov_b64 exec, 1
    ds_write_b128 v241, v[208:211] offset:3088
    s_mov_b64 exec, -1
    s_waitcnt lgkmcnt(0)
    s_barrier
    s_mov_b32 s46, 0x70007000
    s_and_b32 s78, s2, 4
    s_add_u32 s78, s78, s40
    s_xor_b32 s41, s41, 0x30003000
    s_xor_b32 s42, s42, 0x30003000
    s_xor_b32 s43, s43, 0x30003000
    s_xor_b32 s44, s44, 0x30003000
    s_mov_b32 s47, 0x30003000
    s_mov_b32 s45, 20000
    v_mov_b32 v92, 0
    v_mov_b32 v93, 0
    ds_read2_b32 v[64:65], v60 offset0:176 offset1:177
    ds_read2_b32 v[66:67], v60 offset0:178 offset1:179
    ds_read2_b32 v[68:69], v60 offset0:48 offset1:49
    ds_read2_b32 v[70:71], v60 offset0:50 offset1:51
    ds_read2_b32 v[72:73], v61 offset0:176 offset1:177
    ds_read2_b32 v[74:75], v61 offset0:178 offset1:179
    ds_read2_b32 v[76:77], v61 offset0:48 offset1:49
    ds_read2_b32 v[78:79], v61 offset0:50 offset1:51
    ds_read2_b32 v[96:97], v60 offset0:160 offset1:161
    ds_read2_b32 v[98:99], v60 offset0:162 offset1:163
    ds_read2_b32 v[100:101], v60 offset0:32 offset1:33
    ds_read2_b32 v[102:103], v60 offset0:34 offset1:35
    ds_read2_b32 v[104:105], v61 offset0:160 offset1:161
    ds_read2_b32 v[106:107], v61 offset0:162 offset1:163
    ds_read2_b32 v[108:109], v61 offset0:32 offset1:33
    ds_read2_b32 v[110:111], v61 offset0:34 offset1:35
    ds_read2_b32 v[128:129], v60 offset0:144 offset1:145
    ds_read2_b32 v[130:131], v60 offset0:146 offset1:147
    ds_read2_b32 v[132:133], v60 offset0:16 offset1:17
    ds_read2_b32 v[134:135], v60 offset0:18 offset1:19
    ds_read2_b32 v[136:137], v61 offset0:144 offset1:145
    ds_read2_b32 v[138:139], v61 offset0:146 offset1:147
    ds_read2_b32 v[140:141], v61 offset0:16 offset1:17
    ds_read2_b32 v[142:143], v61 offset0:18 offset1:19
    global_load_dwordx4 v[48:51], v56, s[36:37] sc1
    global_load_dwordx4 v[52:55], v57, s[36:37] sc1
    ds_read2_b32 v[160:161], v60 offset0:128 offset1:129
    ds_read2_b32 v[162:163], v60 offset0:130 offset1:131
    ds_read2_b32 v[164:165], v60 offset0:0 offset1:1
    ds_read2_b32 v[166:167], v60 offset0:2 offset1:3
    ds_read2_b32 v[168:169], v61 offset0:128 offset1:129
    ds_read2_b32 v[170:171], v61 offset0:130 offset1:131
    ds_read2_b32 v[172:173], v61 offset0:0 offset1:1
    ds_read2_b32 v[174:175], v61 offset0:2 offset1:3
    ds_read2_b32 v[80:81], v62 offset0:176 offset1:177
    ds_read2_b32 v[82:83], v62 offset0:178 offset1:179
    ds_read2_b32 v[84:85], v237 offset0:0 offset1:1
    ds_read2_b32 v[86:87], v237 offset0:8 offset1:9
    ds_read2_b32 v[88:89], v237 offset0:16 offset1:17
    ds_read2_b32 v[90:91], v237 offset0:24 offset1:25
    v_and_b32 v16, 15, v1
    v_lshrrev_b32 v17, 4, v1
    v_lshlrev_b32 v18, 3, v17
    v_sub_u32 v18, v16, v18
    s_add_u32 s61, s59, 11
    v_add_u32 v18, s61, v18
    s_lshl_b32 s61, s59, 1
    s_add_u32 s61, s61, 6
    v_mov_b32 v19, 0x3f80
    v_mov_b32 v20, 0x3f800000
    v_subrev_u32 v21, 0, v18
    v_subrev_u32 v22, 1, v18
    v_cmp_ge_u32 vcc, s61, v21
    v_cmp_ge_u32 s[76:77], s61, v22
    s_nop 0
    v_cndmask_b32 v21, 0, v19, vcc
    v_cndmask_b32 v22, 0, v20, s[76:77]
    v_or_b32 v246, v21, v22
    v_subrev_u32 v21, 2, v18
    v_subrev_u32 v22, 3, v18
    v_cmp_ge_u32 vcc, s61, v21
    v_cmp_ge_u32 s[76:77], s61, v22
    s_nop 0
    v_cndmask_b32 v21, 0, v19, vcc
    v_cndmask_b32 v22, 0, v20, s[76:77]
    v_or_b32 v247, v21, v22
    v_subrev_u32 v21, 4, v18
    v_subrev_u32 v22, 5, v18
    v_cmp_ge_u32 vcc, s61, v21
    v_cmp_ge_u32 s[76:77], s61, v22
    s_nop 0
    v_cndmask_b32 v21, 0, v19, vcc
    v_cndmask_b32 v22, 0, v20, s[76:77]
    v_or_b32 v248, v21, v22
    v_subrev_u32 v21, 6, v18
    v_subrev_u32 v22, 7, v18
    v_cmp_ge_u32 vcc, s61, v21
    v_cmp_ge_u32 s[76:77], s61, v22
    s_nop 0
    v_cndmask_b32 v21, 0, v19, vcc
    v_cndmask_b32 v22, 0, v20, s[76:77]
    v_or_b32_e64 v249, v21, v22
    s_mul_i32 s61, s59, 240
    s_add_u32 s61, s61, 192
    v_add_u32 v235, s61, v59
    s_lshl_b32 s61, s48, 3
    s_add_u32 s61, s61, s49
    s_lshl_b32 s61, s61, 3
    v_and_b32 v2, 7, v1
    v_add_u32 v2, s61, v2
    s_mul_i32 s61, s40, 114688
    s_add_u32 s61, s61, 262144
    v_lshl_add_u32 v3, v2, 4, s61
    v_lshrrev_b32_e64 v4, 3, v1
    v_lshl_add_u32 v184, v4, 12, v3
    v_add_u32 v185, 0x8000, v184
    v_add_u32 v186, 0x10000, v184
    v_min_u32_e64 v4, 3, v4
    v_lshl_add_u32 v187, v4, 12, v3
    v_add_u32 v187, 0x18000, v187
    s_branch L_e1_chk_21
L_e1_19:
    global_load_dwordx4 v[48:51], v56, s[36:37] sc1
    global_load_dwordx4 v[52:55], v57, s[36:37] sc1
L_e1_chk_21:
    s_waitcnt vmcnt(0)
    v_xor_b32 v48, s41, v48
    v_xor_b32 v49, s42, v49
    v_xor_b32 v50, s43, v50
    v_xor_b32 v51, s44, v51
    ds_write_b128 v58, v[48:51]
    v_xor_b32 v52, s41, v52
    v_xor_b32 v53, s42, v53
    v_xor_b32 v54, s43, v54
    v_xor_b32 v55, s44, v55
    ds_write_b128 v58, v[52:55] offset:2048
    v_xor_b32_e64 v6, s47, v48
    v_bitop3_b32 v6, v6, v49, s47 bitop3:0xf6
    v_bitop3_b32 v6, v6, v50, s47 bitop3:0xf6
    v_bitop3_b32 v6, v6, v51, s47 bitop3:0xf6
    v_bitop3_b32 v6, v6, v52, s47 bitop3:0xf6
    v_bitop3_b32 v6, v6, v53, s47 bitop3:0xf6
    v_bitop3_b32 v6, v6, v54, s47 bitop3:0xf6
    v_bitop3_b32 v6, v6, v55, s47 bitop3:0xf6
    v_and_b32 v6, s46, v6
    v_cmp_ne_u32 vcc, 0, v6
    s_cbranch_vccz L_e1_done_20
    s_sub_u32 s45, s45, 1
    s_cbranch_scc1 L_e1_done_20
    s_lshr_b64 s[74:75], vcc, 1
    s_andn2_b64 s[74:75], s[74:75], s[62:63]
    s_lshl_b64 s[76:77], vcc, 1
    s_and_b64 s[76:77], s[76:77], s[62:63]
    s_or_b64 vcc, vcc, s[74:75]
    s_or_b64 vcc, vcc, s[76:77]
    s_mov_b64 exec, vcc
    s_sleep 1
    s_branch L_e1_19
L_e1_done_20:
    s_mov_b64 exec, -1
    s_setprio 0
    s_waitcnt lgkmcnt(0)
    s_barrier
    ds_read_b128 v[192:195], v59 offset:192
    ds_read_b128 v[196:199], v59 offset:704
    ds_read_b128 v[200:203], v59 offset:1216
    ds_read_b128 v[204:207], v59 offset:1728
    ds_read_b128 v[208:211], v59 offset:128
    ds_read_b128 v[212:215], v59 offset:640
    ds_read_b128 v[216:219], v59 offset:1152
    ds_read_b128 v[220:223], v59 offset:1664
    s_waitcnt lgkmcnt(7)
    s_nop 0
    v_mfma_f32_16x16x32_bf16 v[16:19], v[64:67], v[192:195], 0
    ds_read_b128 v[112:115], v235 offset:0
    v_mfma_f32_16x16x32_bf16 v[20:23], v[68:71], v[192:195], 0
    ds_read_b128 v[116:119], v235 offset:512
    v_mfma_f32_16x16x32_bf16 v[24:27], v[72:75], v[192:195], 0
    ds_read_b128 v[120:123], v235 offset:1024
    v_mfma_f32_16x16x32_bf16 v[28:31], v[76:79], v[192:195], 0
    ds_read_b128 v[124:127], v235 offset:1536
    s_waitcnt lgkmcnt(10)
    v_mfma_f32_16x16x32_bf16 v[20:23], v[64:67], v[196:199], v[20:23]
    ds_read_b128 v[192:195], v59 offset:64
    v_mfma_f32_16x16x32_bf16 v[24:27], v[68:71], v[196:199], v[24:27]
    v_mfma_f32_16x16x32_bf16 v[28:31], v[72:75], v[196:199], v[28:31]
    s_waitcnt lgkmcnt(10)
    v_mfma_f32_16x16x32_bf16 v[24:27], v[64:67], v[200:203], v[24:27]
    ds_read_b128 v[196:199], v59 offset:576
    v_mfma_f32_16x16x32_bf16 v[28:31], v[68:71], v[200:203], v[28:31]
    s_waitcnt lgkmcnt(10)
    v_mfma_f32_16x16x32_bf16 v[28:31], v[64:67], v[204:207], v[28:31]
    ds_read_b128 v[200:203], v59 offset:1088
    s_waitcnt lgkmcnt(10)
    v_mfma_f32_16x16x32_bf16 v[16:19], v[96:99], v[208:211], v[16:19]
    ds_read_b128 v[204:207], v59 offset:1600
    v_mfma_f32_16x16x32_bf16 v[20:23], v[100:103], v[208:211], v[20:23]
    v_mfma_f32_16x16x32_bf16 v[24:27], v[104:107], v[208:211], v[24:27]
    v_mfma_f32_16x16x32_bf16 v[28:31], v[108:111], v[208:211], v[28:31]
    s_waitcnt lgkmcnt(10)
    v_mfma_f32_16x16x32_bf16 v[20:23], v[96:99], v[212:215], v[20:23]
    ds_read_b128 v[208:211], v59 offset:0
    v_mfma_f32_16x16x32_bf16 v[24:27], v[100:103], v[212:215], v[24:27]
    v_mfma_f32_16x16x32_bf16 v[28:31], v[104:107], v[212:215], v[28:31]
    s_waitcnt lgkmcnt(10)
    v_mfma_f32_16x16x32_bf16 v[24:27], v[96:99], v[216:219], v[24:27]
    ds_read_b128 v[212:215], v59 offset:512
    v_mfma_f32_16x16x32_bf16 v[28:31], v[100:103], v[216:219], v[28:31]
    s_waitcnt lgkmcnt(10)
    v_mfma_f32_16x16x32_bf16 v[28:31], v[96:99], v[220:223], v[28:31]
    ds_read_b128 v[216:219], v59 offset:1024
    s_waitcnt lgkmcnt(7)
    v_mfma_f32_16x16x32_bf16 v[144:147], v[112:115], v[246:249], 0
    ds_read_b128 v[220:223], v59 offset:1536
    v_mfma_f32_16x16x32_bf16 v[148:151], v[116:119], v[246:249], 0
    v_mfma_f32_16x16x32_bf16 v[152:155], v[120:123], v[246:249], 0
    v_mfma_f32_16x16x32_bf16 v[156:159], v[124:127], v[246:249], 0
    s_waitcnt lgkmcnt(7)
    v_mfma_f32_16x16x32_bf16 v[16:19], v[128:131], v[192:195], v[16:19]
    v_mfma_f32_16x16x32_bf16 v[20:23], v[132:135], v[192:195], v[20:23]
    v_mfma_f32_16x16x32_bf16 v[24:27], v[136:139], v[192:195], v[24:27]
    v_mfma_f32_16x16x32_bf16 v[28:31], v[140:143], v[192:195], v[28:31]
    s_waitcnt lgkmcnt(6)
    v_mfma_f32_16x16x32_bf16 v[20:23], v[128:131], v[196:199], v[20:23]
    ds_read_b128 v[192:195], v59 offset:192
    v_mfma_f32_16x16x32_bf16 v[24:27], v[132:135], v[196:199], v[24:27]
    v_mfma_f32_16x16x32_bf16 v[28:31], v[136:139], v[196:199], v[28:31]
    v_cvt_pk_bf16_f32 v176, v144, v145
    s_waitcnt lgkmcnt(6)
    v_mfma_f32_16x16x32_bf16 v[24:27], v[128:131], v[200:203], v[24:27]
    ds_read_b128 v[196:199], v59 offset:704
    v_cvt_pk_bf16_f32 v177, v146, v147
    v_mfma_f32_16x16x32_bf16 v[28:31], v[132:135], v[200:203], v[28:31]
    v_cvt_pk_bf16_f32 v178, v148, v149
    s_waitcnt lgkmcnt(6)
    v_mfma_f32_16x16x32_bf16 v[28:31], v[128:131], v[204:207], v[28:31]
    ds_read_b128 v[200:203], v59 offset:1216
    v_cvt_pk_bf16_f32 v179, v150, v151
    s_waitcnt lgkmcnt(6)
    s_nop 0
    v_mfma_f32_16x16x32_bf16 v[16:19], v[160:163], v[208:211], v[16:19]
    ds_read_b128 v[204:207], v59 offset:1728
    v_cvt_pk_bf16_f32 v180, v152, v153
    v_mfma_f32_16x16x32_bf16 v[20:23], v[164:167], v[208:211], v[20:23]
    v_cvt_pk_bf16_f32 v181, v154, v155
    v_mfma_f32_16x16x32_bf16 v[24:27], v[168:171], v[208:211], v[24:27]
    v_cvt_pk_bf16_f32 v182, v156, v157
    v_mfma_f32_16x16x32_bf16 v[28:31], v[172:175], v[208:211], v[28:31]
    v_cvt_pk_bf16_f32 v183, v158, v159
    s_waitcnt lgkmcnt(6)
    v_mfma_f32_16x16x32_bf16 v[20:23], v[160:163], v[212:215], v[20:23]
    ds_read_b128 v[208:211], v59 offset:2240
    v_mfma_f32_16x16x32_bf16 v[24:27], v[164:167], v[212:215], v[24:27]
    v_mfma_f32_16x16x32_bf16 v[28:31], v[168:171], v[212:215], v[28:31]
    s_waitcnt lgkmcnt(6)
    v_mfma_f32_16x16x32_bf16 v[24:27], v[160:163], v[216:219], v[24:27]
    ds_read_b128 v[212:215], v59 offset:2752
    v_mfma_f32_16x16x32_bf16 v[28:31], v[164:167], v[216:219], v[28:31]
    s_waitcnt lgkmcnt(6)
    v_mfma_f32_16x16x32_bf16 v[28:31], v[160:163], v[220:223], v[28:31]
    ds_read_b128 v[216:219], v59 offset:3264
    s_waitcnt lgkmcnt(6)
    v_mfma_f32_16x16x32_bf16 v[32:35], v[80:83], v[192:195], 0
    ds_read_b128 v[220:223], v59 offset:3776
    s_waitcnt lgkmcnt(6)
    v_mfma_f32_16x16x32_bf16 v[32:35], v[76:79], v[196:199], v[32:35]
    ds_read_b128 v[192:195], v59 offset:640
    v_mfma_f32_16x16x32_bf16 v[36:39], v[80:83], v[196:199], 0
    ds_write_b128 v228, v[16:19] offset:0
    s_waitcnt lgkmcnt(7)
    v_mfma_f32_16x16x32_bf16 v[32:35], v[72:75], v[200:203], v[32:35]
    ds_write_b128 v228, v[20:23] offset:1024
    v_mfma_f32_16x16x32_bf16 v[36:39], v[76:79], v[200:203], v[36:39]
    ds_write_b128 v228, v[24:27] offset:2048
    v_mfma_f32_16x16x32_bf16 v[40:43], v[80:83], v[200:203], 0
    ds_write_b128 v228, v[28:31] offset:3072
    s_waitcnt lgkmcnt(9)
    s_nop 0
    v_mfma_f32_16x16x32_bf16 v[32:35], v[68:71], v[204:207], v[32:35]
    ds_read_b128 v[196:199], v59 offset:1152
    v_mfma_f32_16x16x32_bf16 v[36:39], v[72:75], v[204:207], v[36:39]
    ds_read_b128 v[200:203], v59 offset:1664
    v_mfma_f32_16x16x32_bf16 v[40:43], v[76:79], v[204:207], v[40:43]
    v_mfma_f32_16x16x32_bf16 v[44:47], v[80:83], v[204:207], 0
    s_waitcnt lgkmcnt(10)
    v_mfma_f32_16x16x32_bf16 v[32:35], v[64:67], v[208:211], v[32:35]
    ds_read_b128 v[204:207], v59 offset:2176
    v_mfma_f32_16x16x32_bf16 v[36:39], v[68:71], v[208:211], v[36:39]
    s_waitcnt lgkmcnt(3)
    s_barrier
    s_nop 0
    v_mfma_f32_16x16x32_bf16 v[40:43], v[72:75], v[208:211], v[40:43]
    ds_read_b128 v[16:19], v229 offset:8704
    v_mfma_f32_16x16x32_bf16 v[44:47], v[76:79], v[208:211], v[44:47]
    ds_read_b128 v[20:23], v229 offset:16896
    v_mfma_f32_16x16x32_bf16 v[36:39], v[64:67], v[212:215], v[36:39]
    ds_read_b128 v[208:211], v59 offset:2688
    v_mfma_f32_16x16x32_bf16 v[40:43], v[68:71], v[212:215], v[40:43]
    ds_read_b128 v[24:27], v229 offset:43520
    v_mfma_f32_16x16x32_bf16 v[44:47], v[72:75], v[212:215], v[44:47]
    ds_read_b128 v[28:31], v229 offset:51712
    v_mfma_f32_16x16x32_bf16 v[40:43], v[64:67], v[216:219], v[40:43]
    ds_read_b128 v[212:215], v59 offset:3200
    v_mfma_f32_16x16x32_bf16 v[44:47], v[68:71], v[216:219], v[44:47]
    v_mfma_f32_16x16x32_bf16 v[44:47], v[64:67], v[220:223], v[44:47]
    ds_read_b128 v[216:219], v59 offset:3712
    v_mfma_f32_16x16x32_bf16 v[32:35], v[108:111], v[192:195], v[32:35]
    ds_read_b128 v[220:223], v59 offset:576
    s_waitcnt lgkmcnt(10)
    v_mfma_f32_16x16x32_bf16 v[32:35], v[104:107], v[196:199], v[32:35]
    ds_read_b128 v[192:195], v59 offset:1088
    v_mfma_f32_16x16x32_bf16 v[36:39], v[108:111], v[196:199], v[36:39]
    s_waitcnt lgkmcnt(10)
    v_mfma_f32_16x16x32_bf16 v[32:35], v[100:103], v[200:203], v[32:35]
    ds_read_b128 v[196:199], v59 offset:1600
    s_waitcnt lgkmcnt(5)
    v_mfma_f32_16x16x32_bf16 v[36:39], v[104:107], v[200:203], v[36:39]
    v_add_f32 v16, v16, v20
    v_mfma_f32_16x16x32_bf16 v[40:43], v[108:111], v[200:203], v[40:43]
    v_add_f32_e64 v17, v17, v21
    v_mfma_f32_16x16x32_bf16 v[32:35], v[96:99], v[204:207], v[32:35]
    ds_read_b128 v[200:203], v59 offset:2112
    v_add_f32_e64 v18, v18, v22
    v_mfma_f32_16x16x32_bf16 v[36:39], v[100:103], v[204:207], v[36:39]
    v_add_f32_e64 v19, v19, v23
    v_mfma_f32_16x16x32_bf16 v[40:43], v[104:107], v[204:207], v[40:43]
    v_add_f32_e64 v24, v24, v28
    v_mfma_f32_16x16x32_bf16 v[44:47], v[108:111], v[204:207], v[44:47]
    v_add_f32_e64 v25, v25, v29
    v_mfma_f32_16x16x32_bf16 v[36:39], v[96:99], v[208:211], v[36:39]
    ds_read_b128 v[204:207], v59 offset:2624
    v_add_f32_e64 v26, v26, v30
    v_mfma_f32_16x16x32_bf16 v[40:43], v[100:103], v[208:211], v[40:43]
    v_add_f32_e64 v27, v27, v31
    v_mfma_f32_16x16x32_bf16 v[44:47], v[104:107], v[208:211], v[44:47]
    v_cvt_pk_bf16_f32 v48, v16, v24
    s_waitcnt lgkmcnt(6)
    v_mfma_f32_16x16x32_bf16 v[40:43], v[96:99], v[212:215], v[40:43]
    ds_read_b128 v[208:211], v59 offset:3136
    v_cvt_pk_bf16_f32 v49, v17, v25
    v_mfma_f32_16x16x32_bf16 v[44:47], v[100:103], v[212:215], v[44:47]
    v_cvt_pk_bf16_f32 v50, v18, v26
    s_waitcnt lgkmcnt(6)
    v_mfma_f32_16x16x32_bf16 v[44:47], v[96:99], v[216:219], v[44:47]
    ds_read_b128 v[212:215], v59 offset:3648
    v_cvt_pk_bf16_f32 v51, v19, v27
    s_waitcnt lgkmcnt(6)
    v_mfma_f32_16x16x32_bf16 v[32:35], v[140:143], v[220:223], v[32:35]
    ds_read_b128 v[216:219], v59 offset:512
    global_store_dwordx4 v231, v[48:51], s[36:37] offset:-4096 sc1
    s_waitcnt lgkmcnt(6)
    v_mfma_f32_16x16x32_bf16 v[32:35], v[136:139], v[192:195], v[32:35]
    ds_read_b128 v[220:223], v59 offset:1024
    v_mfma_f32_16x16x32_bf16 v[36:39], v[140:143], v[192:195], v[36:39]
    s_waitcnt lgkmcnt(6)
    v_mfma_f32_16x16x32_bf16 v[32:35], v[132:135], v[196:199], v[32:35]
    ds_read_b128 v[192:195], v59 offset:1536
    s_cmp_lg_u32 s78, 3
    s_cbranch_scc1 L_nohu_22
    s_mov_b64 exec, 1
    global_store_dword v244, v242, s[36:37] offset:128
    global_store_dword v244, v242, s[36:37] sc1
    s_mov_b64 exec, -1
L_nohu_22:
    v_mfma_f32_16x16x32_bf16 v[36:39], v[136:139], v[196:199], v[36:39]
    v_mfma_f32_16x16x32_bf16 v[40:43], v[140:143], v[196:199], v[40:43]
    s_waitcnt lgkmcnt(6)
    v_mfma_f32_16x16x32_bf16 v[32:35], v[128:131], v[200:203], v[32:35]
    ds_read_b128 v[196:199], v59 offset:2048
    v_mfma_f32_16x16x32_bf16 v[36:39], v[132:135], v[200:203], v[36:39]
    v_mfma_f32_16x16x32_bf16 v[32:35], v[176:179], v[90:93], v[32:35]
    v_mfma_f32_16x16x32_bf16 v[36:39], v[176:179], v[88:91], v[36:39]
    v_mfma_f32_16x16x32_bf16 v[40:43], v[176:179], v[86:89], v[40:43]
    v_mfma_f32_16x16x32_bf16 v[44:47], v[176:179], v[84:87], v[44:47]
    v_mfma_f32_16x16x32_bf16 v[40:43], v[180:183], v[90:93], v[40:43]
    v_mfma_f32_16x16x32_bf16 v[44:47], v[180:183], v[88:91], v[44:47]
    v_mfma_f32_16x16x32_bf16 v[40:43], v[136:139], v[200:203], v[40:43]
    v_mfma_f32_16x16x32_bf16 v[44:47], v[140:143], v[200:203], v[44:47]
    s_waitcnt lgkmcnt(6)
    v_mfma_f32_16x16x32_bf16 v[36:39], v[128:131], v[204:207], v[36:39]
    ds_read_b128 v[200:203], v59 offset:2560
    v_mfma_f32_16x16x32_bf16 v[40:43], v[132:135], v[204:207], v[40:43]
    s_and_b32 s79, s2, 196
    s_cmp_lg_u32 s79, 0
    s_cbranch_scc1 L_c_norc
    global_load_dwordx4 v[8:11], v232, s[36:37] sc1
L_c_norc:
    v_mfma_f32_16x16x32_bf16 v[44:47], v[136:139], v[204:207], v[44:47]
    s_waitcnt lgkmcnt(6)
    v_mfma_f32_16x16x32_bf16 v[40:43], v[128:131], v[208:211], v[40:43]
    ds_read_b128 v[204:207], v59 offset:3072
    v_mfma_f32_16x16x32_bf16 v[44:47], v[132:135], v[208:211], v[44:47]
    s_waitcnt lgkmcnt(6)
    v_mfma_f32_16x16x32_bf16 v[44:47], v[128:131], v[212:215], v[44:47]
    ds_read_b128 v[208:211], v59 offset:3584
    s_waitcnt lgkmcnt(6)
    v_mfma_f32_16x16x32_bf16 v[32:35], v[172:175], v[216:219], v[32:35]
    s_waitcnt lgkmcnt(5)
    v_mfma_f32_16x16x32_bf16 v[32:35], v[168:171], v[220:223], v[32:35]
    s_waitcnt lgkmcnt(4)
    v_mfma_f32_16x16x32_bf16 v[32:35], v[164:167], v[192:195], v[32:35]
    s_waitcnt lgkmcnt(3)
    v_mfma_f32_16x16x32_bf16 v[32:35], v[160:163], v[196:199], v[32:35]
    v_mfma_f32_16x16x32_bf16 v[36:39], v[172:175], v[220:223], v[36:39]
    v_mfma_f32_16x16x32_bf16 v[36:39], v[168:171], v[192:195], v[36:39]
    v_mfma_f32_16x16x32_bf16 v[36:39], v[164:167], v[196:199], v[36:39]
    s_waitcnt lgkmcnt(2)
    v_mfma_f32_16x16x32_bf16 v[36:39], v[160:163], v[200:203], v[36:39]
    s_nop 2
    ds_write_b128 v228, v[32:35] offset:4096
    v_mfma_f32_16x16x32_bf16 v[40:43], v[172:175], v[192:195], v[40:43]
    v_mfma_f32_16x16x32_bf16 v[40:43], v[168:171], v[196:199], v[40:43]
    v_mfma_f32_16x16x32_bf16 v[40:43], v[164:167], v[200:203], v[40:43]
    s_waitcnt lgkmcnt(2)
    v_mfma_f32_16x16x32_bf16 v[40:43], v[160:163], v[204:207], v[40:43]
    ds_write_b128 v228, v[36:39] offset:5120
    v_mfma_f32_16x16x32_bf16 v[44:47], v[172:175], v[196:199], v[44:47]
    v_mfma_f32_16x16x32_bf16 v[44:47], v[168:171], v[200:203], v[44:47]
    v_mfma_f32_16x16x32_bf16 v[44:47], v[164:167], v[204:207], v[44:47]
    s_waitcnt lgkmcnt(2)
    v_mfma_f32_16x16x32_bf16 v[44:47], v[160:163], v[208:211], v[44:47]
    s_nop 1
    ds_write_b128 v228, v[40:43] offset:6144
    s_nop 4
    ds_write_b128 v228, v[44:47] offset:7168
    s_waitcnt lgkmcnt(0)
    s_barrier
    ds_read_b128 v[16:19], v229 offset:12800
    ds_read_b128 v[20:23], v229 offset:20992
    ds_read_b128 v[24:27], v229 offset:47616
    ds_read_b128 v[28:31], v229 offset:55808
    s_waitcnt lgkmcnt(0)
    v_pk_add_f32 v[16:17], v[16:17], v[20:21]
    v_pk_add_f32 v[18:19], v[18:19], v[22:23]
    v_pk_add_f32 v[24:25], v[24:25], v[28:29]
    v_pk_add_f32 v[26:27], v[26:27], v[30:31]
    v_cvt_pk_bf16_f32 v52, v16, v24
    v_cvt_pk_bf16_f32 v53, v17, v25
    v_cvt_pk_bf16_f32 v54, v18, v26
    v_cvt_pk_bf16_f32 v55, v19, v27
    global_store_dwordx4 v231, v[52:55], s[36:37] offset:0 sc1
    s_cmp_lg_u32 s78, 7
    s_cbranch_scc1 L_nohu_23
    s_mov_b64 exec, 1
    global_store_dword v244, v242, s[36:37] offset:128
    global_store_dword v244, v242, s[36:37] sc1
    s_mov_b64 exec, -1
L_nohu_23:
    s_setprio 0
    s_cmp_lg_u32 s79, 0
    s_cbranch_scc1 L_c_done
    s_waitcnt vmcnt(1)
    v_cmp_ne_u32 vcc, s38, v11
    s_cbranch_vccz L_c_rcok
    s_mov_b32 s45, 20000
L_cr_24:
    global_load_dwordx4 v[8:11], v232, s[36:37] sc1
L_cr_chk_26:
    s_waitcnt vmcnt(0)
    v_cmp_ne_u32 vcc, s38, v11
    s_cbranch_vccz L_cr_done_25
    s_sub_u32 s45, s45, 1
    s_cbranch_scc1 L_cr_done_25
    s_sleep 1
    s_branch L_cr_24
L_cr_done_25:
L_c_rcok:
    v_and_b32 v6, 16, v1
    v_bfe_u32 v7, v1, 5, 1
    v_lshl_add_u32 v5, v2, 1, v7
    v_lshrrev_b32_e64 v8, v6, v8
    v_and_b32 v8, 2047, v8
    v_lshlrev_b32_e64 v60, 1, v5
    v_lshl_add_u32 v61, v8, 10, v60
    global_load_ushort v15, v60, s[20:21] nt
    global_load_ushort v12, v61, s[4:5] nt
    v_lshrrev_b32 v62, 3, v8
    v_lshlrev_b32 v62, 13, v62
    v_lshl_add_u32 v62, v5, 4, v62
    v_add_u32 v62, 1048576, v62
    global_load_dwordx4 v[80:83], v62, s[36:37] sc1
    v_lshlrev_b32_e64 v63, 13, v2
    v_lshl_add_u32 v63, v8, 2, v63
    v_add_u32 v63, 3145728, v63
    v_and_b32_e64 v13, 3, v8
    v_mul_u32_u24 v13, 0x202, v13
    v_lshlrev_b32_e64 v13, 16, v13
    v_add_u32 v13, 0x01000c0c, v13
    v_mov_b32 v14, 0x0c0c0c0c
    v_and_b32 v56, 4, v8
    v_cmp_eq_u32 vcc, 0, v56
    s_nop 1
    v_cndmask_b32 v56, v14, v13, vcc
    v_cndmask_b32_e64 v57, v13, v14, vcc
    s_xor_b32 s64, s41, 805318656
    s_xor_b32 s65, s42, 805318656
    s_xor_b32 s66, s43, 805318656
    s_xor_b32 s67, s44, 805318656
    s_mov_b32 s46, 3216550459
    v_lshrrev_b32 v9, v6, v9
    v_lshlrev_b32 v9, 16, v9
    v_mul_f32 v9, s46, v9
    v_exp_f32 v9, v9
    s_nop 0
    v_add_f32 v9, 1.0, v9
    v_rcp_f32 v9, v9
    s_nop 0
    v_cvt_pk_bf16_f32 v9, 0, v9
    s_bfe_u32 s41, s38, 524288
    s_bfe_u32 s42, s38, 524296
    s_bfe_u32 s43, s38, 524304
    s_bfe_u32 s44, s38, 524312
    s_lshl_b32 s45, s40, 8
    v_lshl_add_u32 v4, v1, 2, s45
    v_lshlrev_b32 v3, 2, v1
    s_mov_b32 s45, 20000
    s_branch L_xg_chk_29
L_xg_27:
    global_load_dwordx4 v[80:83], v62, s[36:37] sc1
L_xg_chk_29:
    s_waitcnt vmcnt(0)
    v_xor_b32 v80, s64, v80
    v_xor_b32 v81, s65, v81
    v_xor_b32 v82, s66, v82
    v_xor_b32 v83, s67, v83
    v_or3_b32 v10, v80, v81, v82
    v_or_b32_e64 v10, v10, v83
    v_and_b32 v10, 0x70007000, v10
    v_cmp_ne_u32 vcc, 0, v10
    s_cbranch_vccz L_xg_done_28
    s_sub_u32 s45, s45, 1
    s_cbranch_scc1 L_xg_done_28
    s_sleep 1
    s_branch L_xg_27
L_xg_done_28:
    s_mov_b32 s45, 20000
    global_load_dwordx4 v[64:67], v184, s[36:37] sc1
    global_load_dwordx4 v[68:71], v185, s[36:37] sc1
    global_load_dwordx4 v[72:75], v186, s[36:37] sc1
    global_load_dwordx4 v[76:79], v187, s[36:37] sc1
    global_load_dword v11, v63, s[36:37] sc1
    v_perm_b32 v10, v81, v80, v56
    v_perm_b32 v14, v83, v82, v57
    s_mov_b32 s47, 0x32000000
    v_add3_u32 v10, v10, v14, s47
    v_lshlrev_b32 v7, 4, v7
    v_lshlrev_b32 v15, 16, v15
    v_lshlrev_b32 v12, 16, v12
    v_mul_f32 v15, v10, v15
    s_branch L_f_chk_32
L_f_30:
    global_load_dwordx4 v[64:67], v184, s[36:37] sc1
    global_load_dwordx4 v[68:71], v185, s[36:37] sc1
    global_load_dwordx4 v[72:75], v186, s[36:37] sc1
    global_load_dwordx4 v[76:79], v187, s[36:37] sc1
    global_load_dword v11, v63, s[36:37] sc1
L_f_chk_32:
    s_waitcnt vmcnt(0)
    v_xor_b32 v64, s41, v64
    v_xor_b32 v65, s42, v65
    v_xor_b32 v66, s43, v66
    v_xor_b32 v67, s44, v67
    v_xor_b32 v68, s41, v68
    v_xor_b32 v69, s42, v69
    v_xor_b32 v70, s43, v70
    v_xor_b32 v71, s44, v71
    v_xor_b32 v72, s41, v72
    v_xor_b32 v73, s42, v73
    v_xor_b32 v74, s43, v74
    v_xor_b32 v75, s44, v75
    v_xor_b32 v76, s41, v76
    v_xor_b32 v77, s42, v77
    v_xor_b32 v78, s43, v78
    v_xor_b32 v79, s44, v79
    v_or3_b32 v6, v64, v65, v66
    v_or3_b32 v6, v6, v67, v68
    v_or3_b32 v6, v6, v69, v70
    v_or3_b32 v6, v6, v71, v72
    v_or3_b32 v6, v6, v73, v74
    v_or3_b32 v6, v6, v75, v76
    v_or3_b32 v6, v6, v77, v78
    v_or_b32_e64 v6, v6, v79
    v_and_b32 v6, 0xff, v6
    v_cmp_ne_u32_e64 vcc, 0, v6
    v_cmp_eq_u32 s[62:63], -1, v11
    s_nop 0
    s_or_b64 vcc, vcc, s[62:63]
    s_cbranch_vccz L_f_done_31
    s_sub_u32 s45, s45, 1
    s_cbranch_scc1 L_f_done_31
    s_mov_b64 exec, vcc
    s_sleep 1
    s_branch L_f_30
L_f_done_31:
    s_mov_b64 exec, -1
    v_pk_add_f32 v[64:65], v[64:65], v[68:69]
    v_pk_add_f32 v[66:67], v[66:67], v[70:71]
    s_mov_b32 exec_hi, 0
    v_pk_add_f32 v[72:73], v[72:73], v[76:77]
    v_pk_add_f32 v[74:75], v[74:75], v[78:79]
    s_mov_b64 exec, -1
    v_pk_add_f32 v[64:65], v[64:65], v[72:73]
    v_pk_add_f32 v[66:67], v[66:67], v[74:75]
    s_nop 0
    v_permlane32_swap_b32 v64, v65
    v_permlane32_swap_b32 v66, v67
    v_add_f32 v64, v64, v65
    v_add_f32 v66, v66, v67
    s_nop 1
    v_permlane16_swap_b32 v64, v66
    v_add_f32 v13, v64, v66
    s_nop 1
    v_add_f32_dpp v13, v13, v13 row_ror:8 row_mask:0xf bank_mask:0xf
    ds_write_b32 v4, v13 offset:25088
    v_lshrrev_b32 v11, v7, v11
    v_lshlrev_b32 v11, 16, v11
    v_add_f32 v11, v15, v11
    s_waitcnt lgkmcnt(0)
    s_barrier
    s_cmp_lg_u32 s40, 0
    s_cbranch_scc1 L_c_done
    ds_read_b32 v16, v3 offset:25344
    ds_read_b32 v17, v3 offset:25600
    ds_read_b32 v18, v3 offset:25856
    s_waitcnt lgkmcnt(0)
    v_add_f32 v13, v13, v16
    v_add_f32 v17, v17, v18
    v_add_f32_e64 v13, v13, v17
    v_cvt_pk_bf16_f32 v13, 0, v13
    v_fma_f32 v13, v13, v9, v10
    v_mul_f32 v9, s46, v13
    v_exp_f32 v9, v9
    v_mul_f32 v13, v13, v11
    v_add_f32 v9, 1.0, v9
    v_rcp_f32 v9, v9
    s_nop 0
    v_fma_f32 v10, v13, v9, v12
    v_cvt_pk_bf16_f32 v10, v10, v10
    s_mov_b32 exec_lo, 0x00ff00ff
    s_mov_b32 exec_hi, 0x00ff00ff
    global_store_short v61, v10, s[32:33]
    s_mov_b64 exec, -1
L_c_done:
L_end:
    s_endpgm
.section .rodata,"a"
.p2align 6
.amdhsa_kernel recurrent_scan__ssm_conv_s4__moe_arch_mod__prompt_kernel
  .amdhsa_next_free_vgpr 256
  .amdhsa_next_free_sgpr 80
  .amdhsa_accum_offset 256
  .amdhsa_group_segment_fixed_size 0
  .amdhsa_kernarg_size 136
  .amdhsa_user_sgpr_count 2
  .amdhsa_user_sgpr_kernarg_segment_ptr 1
  .amdhsa_system_sgpr_workgroup_id_x 1
.end_amdhsa_kernel
```
